```python
import torch

def _softmax(x, axis=-1):
    return torch.softmax(x, dim=axis)

def _gelu(x):
    return torch.nn.functional.gelu(x, approximate='tanh')

def _silu(x):
    return torch.nn.functional.silu(x)

def _sigmoid(x):
    return torch.sigmoid(x)

def _layernorm(x, axis=-1, eps=1e-05):
    m = x.mean(dim=axis, keepdim=True)
    v = x.var(dim=axis, keepdim=True, unbiased=False)
    return (x - m) / torch.sqrt(v + eps)

def _scatter_add(tgt, idx, src, axis=0):
    return tgt.clone().index_add_(axis, idx, src)

def _segment_sum(src, seg, n):
    out = torch.zeros((n,) + src.shape[1:], dtype=src.dtype)
    return out.index_add_(0, seg, src)

def _pad(x, pw):
    flat = tuple((v for pair in reversed(pw) for v in pair))
    return torch.nn.functional.pad(x, flat)
kernel_name = 'sequential_preLN__grouped_kv_mqa__mixer_gmlp__prompt'

def setup_inputs():

    _w = lambda a: (lambda t: t.to(torch.bfloat16) if t.is_floating_point() else t)(torch.as_tensor(a))

    def _A_setup():
        B, S, D, H = (1, 2048, 1024, 32)
        Dh = D // H
        return {'x': _w((lambda *s: torch.randn(*s, dtype=torch.bfloat16) * 0.05)(B, S, D)), 'wq': _w((lambda *s: torch.randn(*s, dtype=torch.bfloat16) * 0.05)(D, H * Dh)), 'wk': _w((lambda *s: torch.randn(*s, dtype=torch.bfloat16) * 0.05)(D, Dh)), 'wv': _w((lambda *s: torch.randn(*s, dtype=torch.bfloat16) * 0.05)(D, Dh)), 'wo': _w((lambda *s: torch.randn(*s, dtype=torch.bfloat16) * 0.05)(H * Dh, D))}
    _A_in = _A_setup()

    def _B_setup():
        B, S, D, F = (1, 2048, 1024, 3584)
        Fh = F // 2
        return {'x': _w((lambda *s: torch.randn(*s, dtype=torch.bfloat16) * 0.05)(B, S, D)), 'w_in': _w((lambda *s: torch.randn(*s, dtype=torch.bfloat16) * 1.6)(D, 2 * Fh)), 'w_sp': _w(0.01 * (lambda *s: torch.randn(*s, dtype=torch.bfloat16) * 1.6)(S, S)), 'b_sp': _w(1.0 + 0.01 * (lambda *s: torch.randn(*s, dtype=torch.bfloat16) * 0.05)(S)), 'w_out': _w((lambda *s: torch.randn(*s, dtype=torch.bfloat16) * 0.05)(Fh, D))}
    _B_in = _B_setup()
    return {'A_x': _A_in['x'], 'A_wq': _A_in['wq'], 'A_wk': _A_in['wk'], 'A_wv': _A_in['wv'], 'A_wo': _A_in['wo'], 'B_x': _B_in['x'], 'B_w_in': _B_in['w_in'], 'B_w_sp': _B_in['w_sp'], 'B_b_sp': _B_in['b_sp'], 'B_w_out': _B_in['w_out']}

def reference(A_x, A_wq, A_wk, A_wv, A_wo, B_x, B_w_in, B_w_sp, B_b_sp, B_w_out):

    def _A_ref(x, wq, wk, wv, wo):
        B, S, D = x.shape
        H = 32
        Dh = D // H
        q = (lambda x, *d: x.permute(*d))((x @ wq).reshape(B, S, H, Dh), 0, 2, 1, 3)
        k = x @ wk
        v = x @ wv
        scores = torch.einsum('bhqd,bkd->bhqk', q, k) * Dh ** (-0.5)
        p = _softmax(scores, axis=-1)
        o = torch.einsum('bhqk,bkd->bhqd', p, v)
        return (lambda x, *d: x.permute(*d))(o, 0, 2, 1, 3).reshape(B, S, H * Dh) @ wo

    def _B_ref(x, w_in, w_sp, b_sp, w_out):
        B, S, D = x.shape
        F = w_in.shape[-1]
        Fh = F // 2
        z = _gelu(torch.einsum('bsd,df->bsf', x, w_in))
        z1 = z[..., :Fh].clone()
        z2 = _layernorm(z[..., Fh:], axis=-1)
        g = torch.einsum('ts,bsf->btf', w_sp, z2) + b_sp[None, :, None]
        return torch.einsum('bsf,fd->bsd', z1 * g, w_out)
    x = A_x
    h = x + _A_ref(_layernorm(x, axis=-1), A_wq, A_wk, A_wv, A_wo)
    h2 = h + _B_ref(_layernorm(h, axis=-1), B_w_in, B_w_sp, B_b_sp, B_w_out)
    return h2
```

```asm
; @launch grid=(256,1,1) block=(512,1,1) lds=163840
.amdgcn_target "amdgcn-amd-amdhsa--gfx950"
.text
.globl sequential_preLN__grouped_kv_mqa__mixer_gmlp__prompt_kernel
.p2align 8
.type sequential_preLN__grouped_kv_mqa__mixer_gmlp__prompt_kernel,@function
sequential_preLN__grouped_kv_mqa__mixer_gmlp__prompt_kernel:
    s_cmp_ge_u32 s2, 256
    s_cbranch_scc1 L_endx
    s_load_dwordx2 s[4:5], s[0:1], 0
    s_load_dwordx2 s[6:7], s[0:1], 8
    s_load_dwordx2 s[8:9], s[0:1], 16
    s_load_dwordx2 s[10:11], s[0:1], 24
    s_load_dwordx2 s[12:13], s[0:1], 96
    s_load_dwordx2 s[14:15], s[0:1], 88
    s_load_dwordx2 s[16:17], s[0:1], 32
    s_load_dwordx2 s[18:19], s[0:1], 48
    s_load_dwordx2 s[20:21], s[0:1], 56
    s_load_dwordx2 s[22:23], s[0:1], 72
    v_lshrrev_b32 v1, 6, v0
    s_nop 0
    v_readfirstlane_b32 s24, v1
    v_and_b32 v1, 63, v0
    s_and_b32 s27, s2, 7
    s_lshr_b32 s25, s27, 1
    s_lshl_b32 s25, s25, 2
    s_and_b32 s26, s27, 1
    s_lshl_b32 s26, s26, 3
    s_lshr_b32 s28, s2, 6
    s_add_u32 s25, s25, s28
    s_lshr_b32 s27, s2, 3
    s_and_b32 s27, s27, 7
    s_add_u32 s26, s26, s27
    v_lshlrev_b32 v2, 4, v1
    s_mov_b32 s34, 83886080
    s_mov_b32 s35, 0x20000
    s_mov_b32 s36, 0
    s_cmp_lg_u32 s24, 0
    s_cbranch_scc1 L_cp_1
    s_getpc_b64 s[60:61]
L_pc_2:
    s_add_u32 s60, s60, sequential_preLN__grouped_kv_mqa__mixer_gmlp__prompt_kernel-L_pc_2
    s_addc_u32 s61, s61, -1
    s_mov_b32 s62, Lz_sequential_preLN__grouped_kv_mqa__mixer_gmlp__prompt_kernel-sequential_preLN__grouped_kv_mqa__mixer_gmlp__prompt_kernel
    s_mov_b32 s63, 0x20000
    s_lshr_b32 s3, s2, 3
    s_lshl_b32 s3, s3, 10
    v_and_b32 v3, 7, v1
    v_lshlrev_b32 v3, 7, v3
    v_lshrrev_b32 v96, 3, v1
    v_lshl_add_u32 v3, v96, 15, v3
    v_add_u32 v3, s3, v3
    buffer_load_dword v96, v3, s[60:63], 0 offen
L_cp_1:
    s_bfe_u32 s56, s2, 0x10003
    s_lshr_b32 s57, s2, 4
    s_and_b32 s3, s2, 7
    s_lshl_b32 s3, s3, 4
    s_add_u32 s57, s57, s3
    s_lshl_b32 s58, s57, 3
    s_add_u32 s58, s58, s24
    s_lshl_b32 s58, s58, 12
    s_mov_b32 s50, 4194304
    s_mov_b32 s51, 0x20000
    s_mov_b32 s62, 65536
    s_mov_b32 s63, 0x20000
    v_and_b32 v3, 32, v1
    v_xor_b32 v11, v2, v3
    s_add_u32 s59, s57, s24
    s_and_b32 s59, s59, 15
    s_lshl_b32 s59, s59, 12
    s_add_u32 m0, s59, 49152
    s_cmp_eq_u32 s56, 0
    s_waitcnt lgkmcnt(0)
    s_mov_b64 s[48:49], s[4:5]
    s_cselect_b64 s[60:61], s[8:9], s[10:11]
    s_lshl_b32 s64, s2, 3
    s_add_u32 s64, s64, s24
    s_cmp_lg_u32 s64, 7
    s_cbranch_scc1 L_r0_3
    s_add_u32 s32, s12, 0
    s_addc_u32 s33, s13, 0
    v_lshrrev_b32 v3, 2, v1
    v_lshlrev_b32 v3, 9, v3
    v_and_b32 v4, 0x30, v2
    v_add_u32 v3, v3, v4
    v_mov_b32 v52, -1
    v_mov_b32 v53, -1
    v_mov_b32 v54, -1
    v_mov_b32 v55, -1
    s_mov_b32 s3, 46268416
    buffer_atomic_swap_x2 v[52:53], v3, s[32:35], s3 offen sc0 sc1
    buffer_atomic_swap_x2 v[54:55], v3, s[32:35], s3 offen offset:8 sc0 sc1
L_r0_3:
    buffer_load_dwordx4 v[20:23], v2, s[48:51], s58 offen offset:0
    buffer_load_dwordx4 v[24:27], v2, s[48:51], s58 offen offset:1024
    buffer_load_dwordx4 v[28:31], v2, s[48:51], s58 offen offset:2048
    buffer_load_dwordx4 v[32:35], v2, s[48:51], s58 offen offset:3072
    s_barrier
    buffer_load_dwordx4 v11, s[60:63], s59 offen offset:0 lds
    buffer_load_dwordx4 v11, s[60:63], s59 offen offset:1024 lds
    buffer_load_dwordx4 v11, s[60:63], s59 offen offset:2048 lds
    buffer_load_dwordx4 v11, s[60:63], s59 offen offset:3072 lds
    s_xor_b32 s59, s59, 0x8000
    s_add_u32 m0, s59, 49152
    s_nop 0
    buffer_load_dwordx4 v11, s[60:63], s59 offen offset:0 lds
    buffer_load_dwordx4 v11, s[60:63], s59 offen offset:1024 lds
    buffer_load_dwordx4 v11, s[60:63], s59 offen offset:2048 lds
    buffer_load_dwordx4 v11, s[60:63], s59 offen offset:3072 lds
    s_mov_b64 s[52:53], s[6:7]
    s_mov_b32 s54, 2097152
    s_mov_b32 s55, 0x20000
    v_and_b32 v3, 7, v1
    v_lshlrev_b32 v3, 7, v3
    s_lshl_b32 s3, s64, 10
    buffer_load_dword v88, v3, s[52:55], s3 offen
    v_lshrrev_b32 v102, 4, v1
    s_add_u32 s32, s12, 0
    s_addc_u32 s33, s13, 0
    v_mov_b32 v100, 0x3f803f80
    v_mul_u32_u24 v101, 272, v1
    s_lshl_b32 s3, s24, 5
    s_add_u32 s3, s3, 114688
    v_add_u32 v101, s3, v101
    v_mul_u32_u24 v103, 272, v102
    v_and_b32 v3, 15, v1
    v_lshl_add_u32 v103, v3, 4, v103
    v_mov_b32 v12, 0
    v_mov_b32 v13, 0
    v_mov_b32 v14, 0
    v_mov_b32 v15, 0
    s_and_b32 s37, s24, 3
    s_lshl_b32 s44, s25, 18
    s_lshl_b32 s45, s26, 7
    s_lshl_b32 s41, s37, 12
    s_lshl_b32 s42, s37, 11
    s_add_u32 s42, s42, 16384
    s_lshr_b32 s3, s24, 2
    s_mul_i32 s40, s3, 24576
    s_mul_i32 s43, s25, 1
    s_add_u32 s43, s43, s3
    s_mul_i32 s3, s26, 0
    s_add_u32 s43, s43, s3
    v_lshrrev_b32 v9, 3, v1
    s_lshl_b32 s3, s37, 5
    v_add_u32 v8, s3, v9
    v_lshrrev_b32 v6, 4, v1
    v_xor_b32 v7, v1, v6
    v_and_b32 v7, 7, v7
    v_lshlrev_b32 v8, 11, v8
    v_lshl_add_u32 v5, v7, 4, v8
    s_lshl_b32 s3, s37, 4
    v_add_u32 v9, s3, v9
    v_lshlrev_b32 v9, 11, v9
    v_lshlrev_b32 v6, 2, v6
    v_xor_b32 v6, v1, v6
    v_and_b32 v6, 7, v6
    v_lshl_add_u32 v9, v6, 4, v9
    v_add_u32 v10, 15360, v9
    v_xor_b32 v6, 64, v5
    v_add_u32 v6, 15360, v6
    v_add_u32 v7, 30720, v5
    v_add_u32 v8, 30720, v6
    s_cmp_lg_u32 s64, 7
    s_waitcnt vmcnt(9)
    s_cbranch_scc1 L_r1_4
    s_mov_b64 s[68:69], s[14:15]
    s_mov_b32 s70, 4
    s_mov_b32 s71, 0x20000
    buffer_store_dword v100, v2, s[68:71], 0 offen sc1
L_r1_4:
    v_dot2c_f32_bf16 v12, v20, v100
    v_dot2c_f32_bf16 v13, v20, v20
    v_dot2c_f32_bf16 v14, v28, v100
    v_dot2c_f32_bf16 v15, v28, v28
    v_dot2c_f32_bf16 v12, v21, v100
    v_dot2c_f32_bf16 v13, v21, v21
    v_dot2c_f32_bf16 v14, v29, v100
    v_dot2c_f32_bf16 v15, v29, v29
    v_dot2c_f32_bf16 v12, v22, v100
    v_dot2c_f32_bf16 v13, v22, v22
    v_dot2c_f32_bf16 v14, v30, v100
    v_dot2c_f32_bf16 v15, v30, v30
    v_dot2c_f32_bf16 v12, v23, v100
    v_dot2c_f32_bf16 v13, v23, v23
    v_dot2c_f32_bf16 v14, v31, v100
    v_dot2c_f32_bf16 v15, v31, v31
    v_dot2c_f32_bf16 v12, v24, v100
    v_dot2c_f32_bf16 v13, v24, v24
    v_dot2c_f32_bf16 v14, v32, v100
    v_dot2c_f32_bf16 v15, v32, v32
    v_dot2c_f32_bf16 v12, v25, v100
    v_dot2c_f32_bf16 v13, v25, v25
    v_dot2c_f32_bf16 v14, v33, v100
    v_dot2c_f32_bf16 v15, v33, v33
    v_dot2c_f32_bf16 v12, v26, v100
    v_dot2c_f32_bf16 v13, v26, v26
    v_dot2c_f32_bf16 v14, v34, v100
    v_dot2c_f32_bf16 v15, v34, v34
    v_dot2c_f32_bf16 v12, v27, v100
    v_dot2c_f32_bf16 v13, v27, v27
    v_dot2c_f32_bf16 v14, v35, v100
    v_dot2c_f32_bf16 v15, v35, v35
    s_nop 2
    v_add_f32_dpp v12, v12, v12 row_shr:1 row_mask:0xf bank_mask:0xf
    v_add_f32_dpp v13, v13, v13 row_shr:1 row_mask:0xf bank_mask:0xf
    v_add_f32_dpp v14, v14, v14 row_shr:1 row_mask:0xf bank_mask:0xf
    v_add_f32_dpp v15, v15, v15 row_shr:1 row_mask:0xf bank_mask:0xf
    v_add_f32_dpp v12, v12, v12 row_shr:2 row_mask:0xf bank_mask:0xf
    v_add_f32_dpp v13, v13, v13 row_shr:2 row_mask:0xf bank_mask:0xf
    v_add_f32_dpp v14, v14, v14 row_shr:2 row_mask:0xf bank_mask:0xf
    v_add_f32_dpp v15, v15, v15 row_shr:2 row_mask:0xf bank_mask:0xf
    v_add_f32_dpp v12, v12, v12 row_shr:4 row_mask:0xf bank_mask:0xf
    v_add_f32_dpp v13, v13, v13 row_shr:4 row_mask:0xf bank_mask:0xf
    v_add_f32_dpp v14, v14, v14 row_shr:4 row_mask:0xf bank_mask:0xf
    v_add_f32_dpp v15, v15, v15 row_shr:4 row_mask:0xf bank_mask:0xf
    v_add_f32_dpp v12, v12, v12 row_shr:8 row_mask:0xf bank_mask:0xf
    v_add_f32_dpp v13, v13, v13 row_shr:8 row_mask:0xf bank_mask:0xf
    v_add_f32_dpp v14, v14, v14 row_shr:8 row_mask:0xf bank_mask:0xf
    v_add_f32_dpp v15, v15, v15 row_shr:8 row_mask:0xf bank_mask:0xf
    v_add_f32_dpp v12, v12, v12 row_bcast:15 row_mask:0xa bank_mask:0xf
    v_add_f32_dpp v13, v13, v13 row_bcast:15 row_mask:0xa bank_mask:0xf
    v_add_f32_dpp v14, v14, v14 row_bcast:15 row_mask:0xa bank_mask:0xf
    v_add_f32_dpp v15, v15, v15 row_bcast:15 row_mask:0xa bank_mask:0xf
    v_add_f32_dpp v12, v12, v12 row_bcast:31 row_mask:0xc bank_mask:0xf
    v_add_f32_dpp v13, v13, v13 row_bcast:31 row_mask:0xc bank_mask:0xf
    v_add_f32_dpp v14, v14, v14 row_bcast:31 row_mask:0xc bank_mask:0xf
    v_add_f32_dpp v15, v15, v15 row_bcast:31 row_mask:0xc bank_mask:0xf
    v_mul_f32 v12, 0xba800000, v12
    v_mul_f32 v13, 0x3a800000, v13
    v_fma_f32 v13, -v12, v12, v13
    v_max_f32 v13, 0, v13
    v_add_f32 v13, 0x3727c5ac, v13
    v_rsq_f32 v13, v13
    s_nop 0
    v_mul_f32 v12, v12, v13
    v_readlane_b32 s72, v13, 63
    v_readlane_b32 s73, v12, 63
    v_mul_f32 v14, 0xba800000, v14
    v_mul_f32 v15, 0x3a800000, v15
    v_fma_f32 v15, -v14, v14, v15
    v_max_f32 v15, 0, v15
    v_add_f32 v15, 0x3727c5ac, v15
    v_rsq_f32 v15, v15
    s_nop 0
    v_mul_f32 v14, v14, v15
    v_readlane_b32 s74, v15, 63
    v_readlane_b32 s75, v14, 63
    v_lshlrev_b32 v16, 16, v20
    v_and_b32 v17, 0xffff0000, v20
    v_pk_fma_f32 v[16:17], v[16:17], s[72:73], s[72:73] op_sel:[0,0,1] op_sel_hi:[1,0,1]
    v_cvt_pk_bf16_f32 v20, v16, v17
    v_lshlrev_b32 v16, 16, v21
    v_and_b32 v17, 0xffff0000, v21
    v_pk_fma_f32 v[16:17], v[16:17], s[72:73], s[72:73] op_sel:[0,0,1] op_sel_hi:[1,0,1]
    v_cvt_pk_bf16_f32 v21, v16, v17
    v_lshlrev_b32 v16, 16, v22
    v_and_b32 v17, 0xffff0000, v22
    v_pk_fma_f32 v[16:17], v[16:17], s[72:73], s[72:73] op_sel:[0,0,1] op_sel_hi:[1,0,1]
    v_cvt_pk_bf16_f32 v22, v16, v17
    v_lshlrev_b32 v16, 16, v23
    v_and_b32 v17, 0xffff0000, v23
    v_pk_fma_f32 v[16:17], v[16:17], s[72:73], s[72:73] op_sel:[0,0,1] op_sel_hi:[1,0,1]
    v_cvt_pk_bf16_f32 v23, v16, v17
    ds_write_b128 v101, v[20:23] offset:0
    v_lshlrev_b32 v16, 16, v24
    v_and_b32 v17, 0xffff0000, v24
    v_pk_fma_f32 v[16:17], v[16:17], s[72:73], s[72:73] op_sel:[0,0,1] op_sel_hi:[1,0,1]
    v_cvt_pk_bf16_f32 v24, v16, v17
    v_lshlrev_b32 v16, 16, v25
    v_and_b32 v17, 0xffff0000, v25
    v_pk_fma_f32 v[16:17], v[16:17], s[72:73], s[72:73] op_sel:[0,0,1] op_sel_hi:[1,0,1]
    v_cvt_pk_bf16_f32 v25, v16, v17
    v_lshlrev_b32 v16, 16, v26
    v_and_b32 v17, 0xffff0000, v26
    v_pk_fma_f32 v[16:17], v[16:17], s[72:73], s[72:73] op_sel:[0,0,1] op_sel_hi:[1,0,1]
    v_cvt_pk_bf16_f32 v26, v16, v17
    v_lshlrev_b32 v16, 16, v27
    v_and_b32 v17, 0xffff0000, v27
    v_pk_fma_f32 v[16:17], v[16:17], s[72:73], s[72:73] op_sel:[0,0,1] op_sel_hi:[1,0,1]
    v_cvt_pk_bf16_f32 v27, v16, v17
    ds_write_b128 v101, v[24:27] offset:17408
    v_lshlrev_b32 v16, 16, v28
    v_and_b32 v17, 0xffff0000, v28
    v_pk_fma_f32 v[16:17], v[16:17], s[74:75], s[74:75] op_sel:[0,0,1] op_sel_hi:[1,0,1]
    v_cvt_pk_bf16_f32 v28, v16, v17
    v_lshlrev_b32 v16, 16, v29
    v_and_b32 v17, 0xffff0000, v29
    v_pk_fma_f32 v[16:17], v[16:17], s[74:75], s[74:75] op_sel:[0,0,1] op_sel_hi:[1,0,1]
    v_cvt_pk_bf16_f32 v29, v16, v17
    v_lshlrev_b32 v16, 16, v30
    v_and_b32 v17, 0xffff0000, v30
    v_pk_fma_f32 v[16:17], v[16:17], s[74:75], s[74:75] op_sel:[0,0,1] op_sel_hi:[1,0,1]
    v_cvt_pk_bf16_f32 v30, v16, v17
    v_lshlrev_b32 v16, 16, v31
    v_and_b32 v17, 0xffff0000, v31
    v_pk_fma_f32 v[16:17], v[16:17], s[74:75], s[74:75] op_sel:[0,0,1] op_sel_hi:[1,0,1]
    v_cvt_pk_bf16_f32 v31, v16, v17
    ds_write_b128 v101, v[28:31] offset:16
    v_lshlrev_b32 v16, 16, v32
    v_and_b32 v17, 0xffff0000, v32
    v_pk_fma_f32 v[16:17], v[16:17], s[74:75], s[74:75] op_sel:[0,0,1] op_sel_hi:[1,0,1]
    v_cvt_pk_bf16_f32 v32, v16, v17
    v_lshlrev_b32 v16, 16, v33
    v_and_b32 v17, 0xffff0000, v33
    v_pk_fma_f32 v[16:17], v[16:17], s[74:75], s[74:75] op_sel:[0,0,1] op_sel_hi:[1,0,1]
    v_cvt_pk_bf16_f32 v33, v16, v17
    v_lshlrev_b32 v16, 16, v34
    v_and_b32 v17, 0xffff0000, v34
    v_pk_fma_f32 v[16:17], v[16:17], s[74:75], s[74:75] op_sel:[0,0,1] op_sel_hi:[1,0,1]
    v_cvt_pk_bf16_f32 v34, v16, v17
    v_lshlrev_b32 v16, 16, v35
    v_and_b32 v17, 0xffff0000, v35
    v_pk_fma_f32 v[16:17], v[16:17], s[74:75], s[74:75] op_sel:[0,0,1] op_sel_hi:[1,0,1]
    v_cvt_pk_bf16_f32 v35, v16, v17
    ds_write_b128 v101, v[32:35] offset:17424
    s_and_b32 s43, s43, 15
    s_lshl_b32 s38, s43, 7
    s_add_u32 s38, s38, s44
    s_add_u32 m0, s40, s41
    s_lshl_b32 s39, s43, 17
    buffer_load_dwordx4 v5, s[48:51], s38 offen offset:0 lds
    buffer_load_dwordx4 v6, s[48:51], s38 offen offset:1024 lds
    buffer_load_dwordx4 v7, s[48:51], s38 offen offset:2048 lds
    buffer_load_dwordx4 v8, s[48:51], s38 offen offset:3072 lds
    s_add_u32 m0, s40, s42
    s_add_u32 s39, s39, s45
    buffer_load_dwordx4 v9, s[52:55], s39 offen lds
    buffer_load_dwordx4 v10, s[52:55], s39 offen offset:1024 lds
    s_add_u32 s43, s43, 1
    s_add_u32 s40, s40, 24576
    s_cmp_eq_u32 s40, 98304
    s_cselect_b32 s40, 0, s40
    v_mov_b32 v84, s72
    v_mov_b32 v85, s73
    v_mov_b32 v86, s74
    v_mov_b32 v87, s75
    s_lshr_b32 s3, s58, 8
    s_add_u32 s3, s3, 4718592
    s_mov_b64 exec, 1
    buffer_store_dwordx4 v[84:87], v2, s[32:35], s3 offen sc1
    s_mov_b64 exec, -1
    s_lshr_b32 s59, s24, 1
    s_mul_i32 s3, s59, 8704
    s_add_u32 s3, s3, 114688
    v_add_u32 v103, s3, v103
    v_lshrrev_b32 v4, 2, v3
    v_lshl_add_u32 v4, v102, 3, v4
    v_lshlrev_b32 v104, 6, v4
    v_and_b32 v4, 3, v1
    v_lshl_add_u32 v104, v4, 3, v104
    v_xor_b32 v4, s24, v102
    v_and_b32 v4, 1, v4
    v_lshl_add_u32 v104, v4, 5, v104
    s_lshl_b32 s3, s59, 14
    s_add_u32 s3, s3, 49152
    v_add_u32 v104, s3, v104
    s_cmp_eq_u32 s56, 1
    s_waitcnt vmcnt(8) lgkmcnt(0)
    s_barrier
    ds_read_b128 v[20:23], v103 offset:0
    ds_read_b64_tr_b16 v[52:53], v104 offset:0
    ds_read_b64_tr_b16 v[54:55], v104 offset:256
    ds_read_b128 v[24:27], v103 offset:1088
    ds_read_b64_tr_b16 v[56:57], v104 offset:2048
    ds_read_b64_tr_b16 v[58:59], v104 offset:2304
    ds_read_b128 v[28:31], v103 offset:2176
    ds_read_b64_tr_b16 v[60:61], v104 offset:4096
    ds_read_b64_tr_b16 v[62:63], v104 offset:4352
    ds_read_b128 v[32:35], v103 offset:3264
    ds_read_b64_tr_b16 v[64:65], v104 offset:6144
    ds_read_b64_tr_b16 v[66:67], v104 offset:6400
    ds_read_b128 v[36:39], v103 offset:4352
    ds_read_b64_tr_b16 v[68:69], v104 offset:8192
    ds_read_b64_tr_b16 v[70:71], v104 offset:8448
    ds_read_b128 v[40:43], v103 offset:5440
    ds_read_b64_tr_b16 v[72:73], v104 offset:10240
    ds_read_b64_tr_b16 v[74:75], v104 offset:10496
    ds_read_b128 v[44:47], v103 offset:6528
    ds_read_b64_tr_b16 v[76:77], v104 offset:12288
    ds_read_b64_tr_b16 v[78:79], v104 offset:12544
    ds_read_b128 v[48:51], v103 offset:7616
    ds_read_b64_tr_b16 v[80:81], v104 offset:14336
    ds_read_b64_tr_b16 v[82:83], v104 offset:14592
    v_lshlrev_b32 v103, 4, v0
    s_waitcnt lgkmcnt(0)
    s_cbranch_scc1 L_v_5
    v_mfma_f32_16x16x32_bf16 v[96:99], v[52:55], v[20:23], 0
    v_mfma_f32_16x16x32_bf16 v[96:99], v[56:59], v[24:27], v[96:99]
    v_mfma_f32_16x16x32_bf16 v[96:99], v[60:63], v[28:31], v[96:99]
    v_mfma_f32_16x16x32_bf16 v[96:99], v[64:67], v[32:35], v[96:99]
    v_mfma_f32_16x16x32_bf16 v[96:99], v[68:71], v[36:39], v[96:99]
    v_mfma_f32_16x16x32_bf16 v[96:99], v[72:75], v[40:43], v[96:99]
    v_mfma_f32_16x16x32_bf16 v[96:99], v[76:79], v[44:47], v[96:99]
    v_mfma_f32_16x16x32_bf16 v[96:99], v[80:83], v[48:51], v[96:99]
    s_branch L_j_6
L_v_5:
    v_mfma_f32_16x16x32_bf16 v[96:99], v[20:23], v[52:55], 0
    v_mfma_f32_16x16x32_bf16 v[96:99], v[24:27], v[56:59], v[96:99]
    v_mfma_f32_16x16x32_bf16 v[96:99], v[28:31], v[60:63], v[96:99]
    v_mfma_f32_16x16x32_bf16 v[96:99], v[32:35], v[64:67], v[96:99]
    v_mfma_f32_16x16x32_bf16 v[96:99], v[36:39], v[68:71], v[96:99]
    v_mfma_f32_16x16x32_bf16 v[96:99], v[40:43], v[72:75], v[96:99]
    v_mfma_f32_16x16x32_bf16 v[96:99], v[44:47], v[76:79], v[96:99]
    v_mfma_f32_16x16x32_bf16 v[96:99], v[48:51], v[80:83], v[96:99]
L_j_6:
    v_add_u32 v103, 155648, v103
    s_and_b32 s3, s57, 1
    s_cmp_eq_u32 s56, 0
    s_cselect_b32 s76, s24, s3
    s_cselect_b32 s77, s3, s24
    s_lshr_b32 s59, s57, 1
    s_lshl_b32 s59, s59, 1
    s_add_u32 s59, s59, s56
    s_lshl_b32 s59, s59, 1
    s_cmp_lt_u32 s24, 2
    s_cselect_b64 exec, 0, -1
    ds_write_b128 v103, v[96:99]
    s_mov_b64 exec, -1
    s_add_u32 s59, s59, s76
    s_lshl_b32 s59, s59, 2
    s_add_u32 s59, s59, s77
    s_lshl_b32 s59, s59, 8
    s_add_u32 s59, s59, 4194304
    v_lshlrev_b32 v3, 4, v3
    v_and_b32 v4, 1, v102
    v_lshl_add_u32 v3, v4, 9, v3
    v_lshrrev_b32 v4, 1, v102
    v_lshl_add_u32 v3, v4, 3, v3
    s_cmp_ge_u32 s24, 2
    s_waitcnt vmcnt(0) lgkmcnt(0)
    s_barrier
    s_cbranch_scc1 L_k_7
    ds_read_b128 v[56:59], v103 offset:2048
    ds_read_b128 v[60:63], v103 offset:4096
    ds_read_b128 v[64:67], v103 offset:6144
    s_waitcnt lgkmcnt(0)
    v_pk_add_f32 v[96:97], v[96:97], v[56:57]
    v_pk_add_f32 v[98:99], v[98:99], v[58:59]
    v_pk_add_f32 v[60:61], v[60:61], v[64:65]
    v_pk_add_f32 v[62:63], v[62:63], v[66:67]
    v_pk_add_f32 v[96:97], v[96:97], v[60:61]
    v_pk_add_f32 v[98:99], v[98:99], v[62:63]
    v_cvt_pk_bf16_f32 v52, v96, v97
    v_cvt_pk_bf16_f32 v53, v98, v99
    buffer_store_dwordx2 v[52:53], v3, s[32:35], s59 offen sc1
L_k_7:
    s_cmp_ge_u32 s24, 4
    s_cbranch_scc1 L_k_7x
    v_mov_b32 v4, -1
    v_lshlrev_b32 v3, 2, v1
    s_lshl_b32 s59, s2, 2
    s_add_u32 s59, s59, s24
    s_lshl_b32 s59, s59, 8
    s_add_u32 s3, s59, 29360128
    buffer_store_dword v4, v3, s[32:35], s3 offen sc1
    s_add_u32 s3, s59, 13631488
    buffer_store_dword v4, v3, s[32:35], s3 offen sc1
    s_and_b32 s59, s59, 0x1ffff
    s_add_u32 s3, s59, 0x2C00000
    buffer_store_dword v4, v3, s[32:35], s3 offen sc1
L_k_7x:
    s_cmp_lt_u32 s24, 4
    s_cbranch_scc1 L_comp_8
    s_and_b32 s43, s43, 15
    s_lshl_b32 s38, s43, 7
    s_add_u32 s38, s38, s44
    s_add_u32 m0, s40, s41
    s_lshl_b32 s39, s43, 17
    buffer_load_dwordx4 v5, s[48:51], s38 offen offset:0 lds
    buffer_load_dwordx4 v6, s[48:51], s38 offen offset:1024 lds
    buffer_load_dwordx4 v7, s[48:51], s38 offen offset:2048 lds
    buffer_load_dwordx4 v8, s[48:51], s38 offen offset:3072 lds
    s_add_u32 m0, s40, s42
    s_add_u32 s39, s39, s45
    buffer_load_dwordx4 v9, s[52:55], s39 offen lds
    buffer_load_dwordx4 v10, s[52:55], s39 offen offset:1024 lds
    s_add_u32 s43, s43, 1
    s_add_u32 s40, s40, 24576
    s_cmp_eq_u32 s40, 98304
    s_cselect_b32 s40, 0, s40
    s_and_b32 s43, s43, 15
    s_lshl_b32 s38, s43, 7
    s_add_u32 s38, s38, s44
    s_add_u32 m0, s40, s41
    s_lshl_b32 s39, s43, 17
    buffer_load_dwordx4 v5, s[48:51], s38 offen offset:0 lds
    buffer_load_dwordx4 v6, s[48:51], s38 offen offset:1024 lds
    buffer_load_dwordx4 v7, s[48:51], s38 offen offset:2048 lds
    buffer_load_dwordx4 v8, s[48:51], s38 offen offset:3072 lds
    s_add_u32 m0, s40, s42
    s_add_u32 s39, s39, s45
    buffer_load_dwordx4 v9, s[52:55], s39 offen lds
    buffer_load_dwordx4 v10, s[52:55], s39 offen offset:1024 lds
    s_add_u32 s43, s43, 1
    s_add_u32 s40, s40, 24576
    s_cmp_eq_u32 s40, 98304
    s_cselect_b32 s40, 0, s40
    s_lshl_b32 s58, s37, 13
    v_add_u32 v11, s58, v2
    s_mov_b32 s57, 4194304
    s_mov_b64 s[76:77], s[32:33]
    s_mov_b32 s79, 0x20000
    v_lshrrev_b32 v32, 2, v1
    v_lshlrev_b32 v32, 9, v32
    v_and_b32 v3, 0x30, v2
    v_add_u32 v32, v32, v3
    v_add_u32 v32, 46268416, v32
    s_cmp_eq_u32 s37, 3
    s_cselect_b32 s78, s34, 0
    s_barrier
    s_and_b32 s43, s43, 15
    s_lshl_b32 s38, s43, 7
    s_add_u32 s38, s38, s44
    s_add_u32 m0, s40, s41
    s_lshl_b32 s39, s43, 17
    buffer_load_dwordx4 v5, s[48:51], s38 offen offset:0 lds
    buffer_load_dwordx4 v6, s[48:51], s38 offen offset:1024 lds
    buffer_load_dwordx4 v7, s[48:51], s38 offen offset:2048 lds
    buffer_load_dwordx4 v8, s[48:51], s38 offen offset:3072 lds
    s_add_u32 m0, s40, s42
    s_add_u32 s39, s39, s45
    buffer_load_dwordx4 v9, s[52:55], s39 offen lds
    buffer_load_dwordx4 v10, s[52:55], s39 offen offset:1024 lds
    s_add_u32 s43, s43, 1
    s_add_u32 s40, s40, 24576
    s_cmp_eq_u32 s40, 98304
    s_cselect_b32 s40, 0, s40
    s_mov_b32 s56, 8
L_ll_10:
    s_waitcnt vmcnt(12)
    s_barrier
    s_and_b32 s43, s43, 15
    s_lshl_b32 s38, s43, 7
    s_add_u32 s38, s38, s44
    s_add_u32 m0, s40, s41
    s_lshl_b32 s39, s43, 17
    buffer_load_dwordx4 v5, s[48:51], s38 offen offset:0 lds
    buffer_load_dwordx4 v6, s[48:51], s38 offen offset:1024 lds
    buffer_load_dwordx4 v7, s[48:51], s38 offen offset:2048 lds
    buffer_load_dwordx4 v8, s[48:51], s38 offen offset:3072 lds
    s_add_u32 m0, s40, s42
    s_add_u32 s39, s39, s45
    buffer_load_dwordx4 v9, s[52:55], s39 offen lds
    buffer_load_dwordx4 v10, s[52:55], s39 offen offset:1024 lds
    s_add_u32 s43, s43, 1
    s_add_u32 s40, s40, 24576
    s_cmp_eq_u32 s40, 98304
    s_cselect_b32 s40, 0, s40
    s_sub_u32 s56, s56, 1
    s_cmp_lg_u32 s56, 0
    s_nop 7
    s_cbranch_scc1 L_ll_10
    s_waitcnt vmcnt(12)
    s_barrier
    s_and_b32 s43, s43, 15
    s_lshl_b32 s38, s43, 7
    s_add_u32 s38, s38, s44
    s_add_u32 m0, s40, s41
    s_lshl_b32 s39, s43, 17
    buffer_load_dwordx4 v5, s[48:51], s38 offen offset:0 lds
    buffer_load_dwordx4 v6, s[48:51], s38 offen offset:1024 lds
    buffer_load_dwordx4 v7, s[48:51], s38 offen offset:2048 lds
    buffer_load_dwordx4 v8, s[48:51], s38 offen offset:3072 lds
    s_add_u32 m0, s40, s42
    s_add_u32 s39, s39, s45
    buffer_load_dwordx4 v9, s[52:55], s39 offen lds
    buffer_load_dwordx4 v10, s[52:55], s39 offen offset:1024 lds
    s_add_u32 s43, s43, 1
    s_add_u32 s40, s40, 24576
    s_cmp_eq_u32 s40, 98304
    s_cselect_b32 s40, 0, s40
    buffer_load_dwordx4 v[12:15], v32, s[76:79], 0 offen sc1
    s_waitcnt vmcnt(13)
    s_barrier
    s_and_b32 s43, s43, 15
    s_lshl_b32 s38, s43, 7
    s_add_u32 s38, s38, s44
    s_add_u32 m0, s40, s41
    s_lshl_b32 s39, s43, 17
    buffer_load_dwordx4 v5, s[48:51], s38 offen offset:0 lds
    buffer_load_dwordx4 v6, s[48:51], s38 offen offset:1024 lds
    buffer_load_dwordx4 v7, s[48:51], s38 offen offset:2048 lds
    buffer_load_dwordx4 v8, s[48:51], s38 offen offset:3072 lds
    s_add_u32 m0, s40, s42
    s_add_u32 s39, s39, s45
    buffer_load_dwordx4 v9, s[52:55], s39 offen lds
    buffer_load_dwordx4 v10, s[52:55], s39 offen offset:1024 lds
    s_add_u32 s43, s43, 1
    s_add_u32 s40, s40, 24576
    s_cmp_eq_u32 s40, 98304
    s_cselect_b32 s40, 0, s40
    s_waitcnt vmcnt(13)
    s_barrier
    s_and_b32 s43, s43, 15
    s_lshl_b32 s38, s43, 7
    s_add_u32 s38, s38, s44
    s_add_u32 m0, s40, s41
    s_lshl_b32 s39, s43, 17
    buffer_load_dwordx4 v5, s[48:51], s38 offen offset:0 lds
    buffer_load_dwordx4 v6, s[48:51], s38 offen offset:1024 lds
    buffer_load_dwordx4 v7, s[48:51], s38 offen offset:2048 lds
    buffer_load_dwordx4 v8, s[48:51], s38 offen offset:3072 lds
    s_add_u32 m0, s40, s42
    s_add_u32 s39, s39, s45
    buffer_load_dwordx4 v9, s[52:55], s39 offen lds
    buffer_load_dwordx4 v10, s[52:55], s39 offen offset:1024 lds
    s_add_u32 s43, s43, 1
    s_add_u32 s40, s40, 24576
    s_cmp_eq_u32 s40, 98304
    s_cselect_b32 s40, 0, s40
    s_waitcnt vmcnt(12)
L_p_9:
    v_or3_b32 v12, v12, v13, v14
    v_or_b32 v12, v12, v15
    v_cmp_ne_u32 vcc, 0, v12
    s_cbranch_vccz L_p_9x
    s_sleep 6
    buffer_load_dwordx4 v[12:15], v32, s[76:79], 0 offen sc1
    s_waitcnt vmcnt(0)
    s_branch L_p_9
L_p_9x:
    s_waitcnt vmcnt(13)
    s_barrier
    v_lshrrev_b32 v3, 4, v1
    v_lshlrev_b32 v3, 12, v3
    v_and_b32 v4, 0xf0, v2
    v_add_u32 v3, v3, v4
    s_lshl_b32 s59, s26, 8
    s_add_u32 s59, s59, 4784128
    buffer_load_dwordx4 v[12:15], v3, s[32:35], s59 offen sc1
    s_add_u32 s59, s59, 16384
    buffer_load_dwordx4 v[16:19], v3, s[32:35], s59 offen sc1
    s_add_u32 s59, s59, 16384
    buffer_load_dwordx4 v[20:23], v3, s[32:35], s59 offen sc1
    s_add_u32 s59, s59, 16384
    buffer_load_dwordx4 v[24:27], v3, s[32:35], s59 offen sc1
    s_add_u32 s59, s59, 16384
    s_lshl_b32 s59, s25, 10
    s_add_u32 s59, s59, 4718592
    buffer_load_dwordx4 v[28:31], v2, s[32:35], s59 offen sc1
    s_add_u32 m0, s58, 98304
    s_nop 0
    buffer_load_dwordx4 v11, s[32:35], s57 offen offset:0 sc1 lds
    buffer_load_dwordx4 v11, s[32:35], s57 offen offset:1024 sc1 lds
    buffer_load_dwordx4 v11, s[32:35], s57 offen offset:2048 sc1 lds
    buffer_load_dwordx4 v11, s[32:35], s57 offen offset:3072 sc1 lds
    s_add_u32 s57, s57, 4096
    s_add_u32 m0, s58, 102400
    s_nop 0
    buffer_load_dwordx4 v11, s[32:35], s57 offen offset:0 sc1 lds
    buffer_load_dwordx4 v11, s[32:35], s57 offen offset:1024 sc1 lds
    buffer_load_dwordx4 v11, s[32:35], s57 offen offset:2048 sc1 lds
    buffer_load_dwordx4 v11, s[32:35], s57 offen offset:3072 sc1 lds
    s_add_u32 s57, s57, 28672
    s_waitcnt vmcnt(19)
    s_barrier
    s_mov_b64 s[64:65], s[18:19]
    s_mov_b32 s66, 7340032
    s_mov_b32 s67, 0x20000
    s_mov_b64 s[68:69], s[20:21]
    s_mov_b32 s70, 8388608
    s_mov_b32 s71, 0x20000
    s_mov_b64 s[72:73], s[22:23]
    s_mov_b32 s74, 3670016
    s_mov_b32 s75, 0x20000
    s_mov_b64 s[76:77], s[16:17]
    s_mov_b32 s78, 2097152
    s_mov_b32 s79, 0x20000
    v_lshrrev_b32 v3, 3, v1
    v_and_b32 v4, 7, v1
    v_lshrrev_b32 v35, 4, v1
    v_lshlrev_b32 v34, 1, v35
    v_xor_b32 v34, v34, v4
    v_lshlrev_b32 v34, 4, v34
    v_mul_u32_u24 v33, 7168, v3
    v_add_u32 v33, v33, v34
    v_lshl_add_u32 v34, v3, 11, v34
    v_xor_b32 v35, v35, v4
    v_lshlrev_b32 v35, 4, v35
    v_lshl_add_u32 v35, v3, 12, v35
    v_xor_b32 v36, 64, v35
    s_mul_i32 s86, s37, 12288
    s_add_u32 s86, s86, 0
    v_lshrrev_b32 v3, 2, v1
    v_lshlrev_b32 v37, 7, v3
    v_and_b32 v3, 3, v1
    v_lshl_add_u32 v37, v3, 3, v37
    v_bfe_u32 v3, v1, 3, 2
    v_lshl_add_u32 v37, v3, 5, v37
    v_add_u32 v37, s86, v37
    v_and_b32 v3, 15, v1
    v_lshlrev_b32 v38, 7, v3
    v_lshrrev_b32 v3, 1, v3
    v_lshrrev_b32 v4, 5, v1
    v_xor_b32 v3, v3, v4
    v_lshl_add_u32 v38, v3, 4, v38
    v_bfe_u32 v3, v1, 4, 1
    v_lshl_add_u32 v38, v3, 3, v38
    v_add_u32 v38, s86, v38
    v_lshlrev_b32 v39, 7, v1
    v_mov_b32 v72, 0x3f803f80
    v_mov_b32 v73, 0x3f803f80
    v_mov_b32 v74, 0x3f803f80
    v_mov_b32 v75, 0x3f803f80
    s_waitcnt vmcnt(13)
    s_barrier
    s_waitcnt vmcnt(8)
    v_add_f32 v12, v12, v20
    v_add_f32 v13, v13, v21
    v_add_f32 v14, v14, v22
    v_add_f32 v15, v15, v23
    v_add_f32 v16, v16, v24
    v_add_f32 v17, v17, v25
    v_add_f32 v18, v18, v26
    v_add_f32 v19, v19, v27
    v_add_f32 v12, v12, v16
    v_add_f32 v13, v13, v17
    v_add_f32 v14, v14, v18
    v_add_f32 v15, v15, v19
    v_mov_b32 v16, v12
    v_mov_b32 v17, v13
    v_mov_b32 v18, v14
    v_mov_b32 v19, v15
    s_nop 0
    v_permlane32_swap_b32 v12, v16
    v_permlane32_swap_b32 v13, v17
    v_permlane32_swap_b32 v14, v18
    v_permlane32_swap_b32 v15, v19
    s_nop 0
    v_add_f32 v12, v12, v16
    v_add_f32 v13, v13, v17
    v_add_f32 v14, v14, v18
    v_add_f32 v15, v15, v19
    v_mov_b32 v16, v12
    v_mov_b32 v17, v13
    v_mov_b32 v18, v14
    v_mov_b32 v19, v15
    s_nop 0
    v_permlane16_swap_b32 v12, v16
    v_permlane16_swap_b32 v13, v17
    v_permlane16_swap_b32 v14, v18
    v_permlane16_swap_b32 v15, v19
    s_nop 0
    v_add_f32 v12, v12, v16
    v_add_f32 v13, v13, v17
    v_add_f32 v14, v14, v18
    v_add_f32 v15, v15, v19
    v_and_b32 v4, 0xf0, v2
    ds_write_b128 v4, v[12:15] offset:8192
    ds_write_b128 v2, v[28:31] offset:8448
    s_sub_u32 s3, s2, 32
    s_cmp_lt_u32 s2, 224
    s_cselect_b32 s60, s2, s3
    s_mul_i32 s85, s60, 1171
    s_lshr_b32 s85, s85, 16
    s_mul_i32 s3, s85, 56
    s_sub_u32 s84, s60, s3
    s_cmp_ge_u32 s84, 28
    s_cselect_b32 s90, 112, 0
    s_cselect_b32 s91, 6, 8
    s_mov_b32 s88, 3703203139
    s_mov_b32 s89, 14464596
    s_cmov_b32 s88, 278426128
    s_cmov_b32 s89, 11110194
    s_lshl_b32 s3, s84, 2
    s_sub_u32 s90, s3, s90
    s_lshl_b32 s85, s85, 3
    s_add_u32 s85, s85, s37
    s_cmp_ge_u32 s84, 28
    s_cselect_b32 s91, 0, 229376
    s_mul_i32 s3, s85, 7168
    s_add_u32 s91, s91, s3
    s_add_u32 s91, s91, 37748736
    s_add_u32 s92, s90, 0
    s_mul_i32 s3, s92, 147
    s_lshr_b32 s3, s3, 10
    s_mul_i32 s3, s3, 451584
    s_lshl_b32 s92, s92, 10
    s_add_u32 s92, s92, s3
    s_add_u32 s80, s92, s91
    s_add_u32 s92, s90, 1
    s_mul_i32 s3, s92, 147
    s_lshr_b32 s3, s3, 10
    s_mul_i32 s3, s3, 451584
    s_lshl_b32 s92, s92, 10
    s_add_u32 s92, s92, s3
    s_add_u32 s81, s92, s91
    s_add_u32 s92, s90, 2
    s_mul_i32 s3, s92, 147
    s_lshr_b32 s3, s3, 10
    s_mul_i32 s3, s3, 451584
    s_lshl_b32 s92, s92, 10
    s_add_u32 s92, s92, s3
    s_add_u32 s82, s92, s91
    s_add_u32 s92, s90, 3
    s_mul_i32 s3, s92, 147
    s_lshr_b32 s3, s3, 10
    s_mul_i32 s3, s3, 451584
    s_lshl_b32 s92, s92, 10
    s_add_u32 s92, s92, s3
    s_add_u32 s83, s92, s91
    s_waitcnt vmcnt(0) lgkmcnt(0)
    s_barrier
    s_add_u32 m0, s58, 131072
    s_nop 0
    buffer_load_dwordx4 v11, s[32:35], s57 offen offset:0 sc1 lds
    buffer_load_dwordx4 v11, s[32:35], s57 offen offset:1024 sc1 lds
    buffer_load_dwordx4 v11, s[32:35], s57 offen offset:2048 sc1 lds
    buffer_load_dwordx4 v11, s[32:35], s57 offen offset:3072 sc1 lds
    s_add_u32 s57, s57, 4096
    s_add_u32 m0, s58, 135168
    s_nop 0
    buffer_load_dwordx4 v11, s[32:35], s57 offen offset:0 sc1 lds
    buffer_load_dwordx4 v11, s[32:35], s57 offen offset:1024 sc1 lds
    buffer_load_dwordx4 v11, s[32:35], s57 offen offset:2048 sc1 lds
    buffer_load_dwordx4 v11, s[32:35], s57 offen offset:3072 sc1 lds
    s_add_u32 s57, s57, 28672
    s_lshl_b32 s60, s2, 2
    s_add_u32 s60, s60, s37
    s_add_u32 s59, s85, 0
    s_mul_i32 s59, s59, 229376
    s_lshl_b32 s3, s84, 7
    s_add_u32 s59, s59, s3
    s_add_u32 m0, s86, 0
    s_nop 0
    buffer_load_dwordx4 v33, s[64:67], s59 offen offset:0 lds
    s_add_u32 s59, s59, 56320
    buffer_load_dwordx4 v33, s[64:67], s59 offen offset:1024 lds
    s_add_u32 s59, s59, 56320
    buffer_load_dwordx4 v33, s[64:67], s59 offen offset:2048 lds
    s_add_u32 s59, s59, 56320
    buffer_load_dwordx4 v33, s[64:67], s59 offen offset:3072 lds
    s_waitcnt vmcnt(4)
    s_barrier
    s_add_u32 m0, s58, 65536
    s_nop 0
    buffer_load_dwordx4 v11, s[32:35], s57 offen offset:0 sc1 lds
    buffer_load_dwordx4 v11, s[32:35], s57 offen offset:1024 sc1 lds
    buffer_load_dwordx4 v11, s[32:35], s57 offen offset:2048 sc1 lds
    buffer_load_dwordx4 v11, s[32:35], s57 offen offset:3072 sc1 lds
    s_add_u32 s57, s57, 4096
    s_add_u32 m0, s58, 69632
    s_nop 0
    buffer_load_dwordx4 v11, s[32:35], s57 offen offset:0 sc1 lds
    buffer_load_dwordx4 v11, s[32:35], s57 offen offset:1024 sc1 lds
    buffer_load_dwordx4 v11, s[32:35], s57 offen offset:2048 sc1 lds
    buffer_load_dwordx4 v11, s[32:35], s57 offen offset:3072 sc1 lds
    s_add_u32 s57, s57, 28672
    s_add_u32 s59, s85, 4
    s_mul_i32 s59, s59, 229376
    s_lshl_b32 s3, s84, 7
    s_add_u32 s59, s59, s3
    s_add_u32 m0, s86, 4096
    s_nop 0
    buffer_load_dwordx4 v33, s[64:67], s59 offen offset:0 lds
    s_add_u32 s59, s59, 56320
    buffer_load_dwordx4 v33, s[64:67], s59 offen offset:1024 lds
    s_add_u32 s59, s59, 56320
    buffer_load_dwordx4 v33, s[64:67], s59 offen offset:2048 lds
    s_add_u32 s59, s59, 56320
    buffer_load_dwordx4 v33, s[64:67], s59 offen offset:3072 lds
    s_waitcnt vmcnt(4)
    s_barrier
    s_add_u32 m0, s58, 98304
    s_nop 0
    buffer_load_dwordx4 v11, s[32:35], s57 offen offset:0 sc1 lds
    buffer_load_dwordx4 v11, s[32:35], s57 offen offset:1024 sc1 lds
    buffer_load_dwordx4 v11, s[32:35], s57 offen offset:2048 sc1 lds
    buffer_load_dwordx4 v11, s[32:35], s57 offen offset:3072 sc1 lds
    s_add_u32 s57, s57, 4096
    s_add_u32 m0, s58, 102400
    s_nop 0
    buffer_load_dwordx4 v11, s[32:35], s57 offen offset:0 sc1 lds
    buffer_load_dwordx4 v11, s[32:35], s57 offen offset:1024 sc1 lds
    buffer_load_dwordx4 v11, s[32:35], s57 offen offset:2048 sc1 lds
    buffer_load_dwordx4 v11, s[32:35], s57 offen offset:3072 sc1 lds
    s_add_u32 s57, s57, 28672
    s_lshr_b32 s59, s60, 5
    s_add_u32 s59, s59, 0
    s_lshl_b32 s59, s59, 17
    s_and_b32 s3, s60, 31
    s_lshl_b32 s3, s3, 7
    s_add_u32 s59, s59, s3
    s_add_u32 m0, s86, 8192
    s_nop 0
    buffer_load_dwordx4 v35, s[68:71], s59 offen offset:0 lds
    s_add_u32 s59, s59, 31744
    buffer_load_dwordx4 v36, s[68:71], s59 offen offset:1024 lds
    s_add_u32 s59, s59, 31744
    buffer_load_dwordx4 v35, s[68:71], s59 offen offset:2048 lds
    s_add_u32 s59, s59, 31744
    buffer_load_dwordx4 v36, s[68:71], s59 offen offset:3072 lds
    s_waitcnt vmcnt(24)
    v_xor_b32 v77, 32, v37
    v_xor_b32 v78, 64, v37
    v_xor_b32 v79, 96, v37
    ds_read_b64_tr_b16 v[40:41], v37 offset:0
    ds_read_b64_tr_b16 v[42:43], v37 offset:2048
    ds_read_b64_tr_b16 v[44:45], v77 offset:0
    ds_read_b64_tr_b16 v[46:47], v77 offset:2048
    ds_read_b64_tr_b16 v[48:49], v78 offset:0
    ds_read_b64_tr_b16 v[50:51], v78 offset:2048
    ds_read_b64_tr_b16 v[52:53], v79 offset:0
    ds_read_b64_tr_b16 v[54:55], v79 offset:2048
    s_waitcnt lgkmcnt(0)
    buffer_store_dwordx4 v[40:43], v2, s[32:35], s80 offen sc1
    v_mfma_f32_16x16x32_bf16 v[56:59], v[72:75], v[40:43], 0
    s_add_u32 s80, s80, 28672
    buffer_store_dwordx4 v[44:47], v2, s[32:35], s81 offen sc1
    v_mfma_f32_16x16x32_bf16 v[60:63], v[72:75], v[44:47], 0
    s_add_u32 s81, s81, 28672
    buffer_store_dwordx4 v[48:51], v2, s[32:35], s82 offen sc1
    v_mfma_f32_16x16x32_bf16 v[64:67], v[72:75], v[48:51], 0
    s_add_u32 s82, s82, 28672
    buffer_store_dwordx4 v[52:55], v2, s[32:35], s83 offen sc1
    v_mfma_f32_16x16x32_bf16 v[68:71], v[72:75], v[52:55], 0
    s_add_u32 s83, s83, 28672
    s_waitcnt vmcnt(8)
    s_barrier
    s_add_u32 m0, s58, 131072
    s_nop 0
    buffer_load_dwordx4 v11, s[32:35], s57 offen offset:0 sc1 lds
    buffer_load_dwordx4 v11, s[32:35], s57 offen offset:1024 sc1 lds
    buffer_load_dwordx4 v11, s[32:35], s57 offen offset:2048 sc1 lds
    buffer_load_dwordx4 v11, s[32:35], s57 offen offset:3072 sc1 lds
    s_add_u32 s57, s57, 4096
    s_add_u32 m0, s58, 135168
    s_nop 0
    buffer_load_dwordx4 v11, s[32:35], s57 offen offset:0 sc1 lds
    buffer_load_dwordx4 v11, s[32:35], s57 offen offset:1024 sc1 lds
    buffer_load_dwordx4 v11, s[32:35], s57 offen offset:2048 sc1 lds
    buffer_load_dwordx4 v11, s[32:35], s57 offen offset:3072 sc1 lds
    s_add_u32 s57, s57, 28672
    s_lshr_b32 s59, s60, 5
    s_add_u32 s59, s59, 32
    s_lshl_b32 s59, s59, 17
    s_and_b32 s3, s60, 31
    s_lshl_b32 s3, s3, 7
    s_add_u32 s59, s59, s3
    s_add_u32 m0, s86, 0
    s_nop 0
    buffer_load_dwordx4 v35, s[68:71], s59 offen offset:0 lds
    s_add_u32 s59, s59, 31744
    buffer_load_dwordx4 v36, s[68:71], s59 offen offset:1024 lds
    s_add_u32 s59, s59, 31744
    buffer_load_dwordx4 v35, s[68:71], s59 offen offset:2048 lds
    s_add_u32 s59, s59, 31744
    buffer_load_dwordx4 v36, s[68:71], s59 offen offset:3072 lds
    s_waitcnt vmcnt(28)
    v_xor_b32 v77, 32, v37
    v_xor_b32 v78, 64, v37
    v_xor_b32 v79, 96, v37
    ds_read_b64_tr_b16 v[40:41], v37 offset:4096
    ds_read_b64_tr_b16 v[42:43], v37 offset:6144
    ds_read_b64_tr_b16 v[44:45], v77 offset:4096
    ds_read_b64_tr_b16 v[46:47], v77 offset:6144
    ds_read_b64_tr_b16 v[48:49], v78 offset:4096
    ds_read_b64_tr_b16 v[50:51], v78 offset:6144
    ds_read_b64_tr_b16 v[52:53], v79 offset:4096
    ds_read_b64_tr_b16 v[54:55], v79 offset:6144
    s_waitcnt lgkmcnt(0)
    buffer_store_dwordx4 v[40:43], v2, s[32:35], s80 offen sc1
    v_mfma_f32_16x16x32_bf16 v[56:59], v[72:75], v[40:43], v[56:59]
    s_add_u32 s80, s80, 28672
    buffer_store_dwordx4 v[44:47], v2, s[32:35], s81 offen sc1
    v_mfma_f32_16x16x32_bf16 v[60:63], v[72:75], v[44:47], v[60:63]
    s_add_u32 s81, s81, 28672
    buffer_store_dwordx4 v[48:51], v2, s[32:35], s82 offen sc1
    v_mfma_f32_16x16x32_bf16 v[64:67], v[72:75], v[48:51], v[64:67]
    s_add_u32 s82, s82, 28672
    buffer_store_dwordx4 v[52:55], v2, s[32:35], s83 offen sc1
    v_mfma_f32_16x16x32_bf16 v[68:71], v[72:75], v[52:55], v[68:71]
    s_add_u32 s83, s83, 28672
    s_waitcnt vmcnt(8)
    s_barrier
    s_add_u32 m0, s58, 65536
    s_nop 0
    buffer_load_dwordx4 v11, s[32:35], s57 offen offset:0 sc1 lds
    buffer_load_dwordx4 v11, s[32:35], s57 offen offset:1024 sc1 lds
    buffer_load_dwordx4 v11, s[32:35], s57 offen offset:2048 sc1 lds
    buffer_load_dwordx4 v11, s[32:35], s57 offen offset:3072 sc1 lds
    s_add_u32 s57, s57, 4096
    s_add_u32 m0, s58, 69632
    s_nop 0
    buffer_load_dwordx4 v11, s[32:35], s57 offen offset:0 sc1 lds
    buffer_load_dwordx4 v11, s[32:35], s57 offen offset:1024 sc1 lds
    buffer_load_dwordx4 v11, s[32:35], s57 offen offset:2048 sc1 lds
    buffer_load_dwordx4 v11, s[32:35], s57 offen offset:3072 sc1 lds
    s_add_u32 s57, s57, 28672
    s_sub_u32 s3, s60, 128
    s_cmp_lt_u32 s60, 896
    s_cselect_b32 s90, s60, s3
    s_lshr_b32 s59, s90, 4
    s_lshl_b32 s59, s59, 16
    s_and_b32 s3, s90, 15
    s_lshl_b32 s3, s3, 7
    s_add_u32 s59, s59, s3
    s_add_u32 m0, s86, 4096
    s_nop 0
    buffer_load_dwordx4 v34, s[72:75], s59 offen offset:0 lds
    s_add_u32 s59, s59, 15360
    buffer_load_dwordx4 v34, s[72:75], s59 offen offset:1024 lds
    s_add_u32 s59, s59, 15360
    buffer_load_dwordx4 v34, s[72:75], s59 offen offset:2048 lds
    s_add_u32 s59, s59, 15360
    buffer_load_dwordx4 v34, s[72:75], s59 offen offset:3072 lds
    s_waitcnt vmcnt(32)
    v_xor_b32 v77, 32, v38
    v_xor_b32 v78, 64, v38
    v_xor_b32 v79, 96, v38
    ds_read_b64 v[40:41], v38 offset:8192
    ds_read_b64 v[42:43], v77 offset:8192
    ds_read_b64 v[44:45], v38 offset:10240
    ds_read_b64 v[46:47], v77 offset:10240
    ds_read_b64 v[48:49], v78 offset:8192
    ds_read_b64 v[50:51], v79 offset:8192
    ds_read_b64 v[52:53], v78 offset:10240
    ds_read_b64 v[54:55], v79 offset:10240
    s_lshr_b32 s91, s60, 5
    s_add_u32 s91, s91, 0
    s_lshr_b32 s92, s91, 2
    s_lshl_b32 s92, s92, 19
    s_and_b32 s3, s91, 3
    s_lshl_b32 s3, s3, 11
    s_add_u32 s92, s92, s3
    s_and_b32 s3, s60, 31
    s_lshl_b32 s3, s3, 14
    s_add_u32 s92, s92, s3
    s_add_u32 s92, s92, 67108864
    s_add_u32 s91, s92, 8192
    s_waitcnt lgkmcnt(0)
    buffer_store_dwordx4 v[40:43], v2, s[32:35], s92 offen offset:0 sc1
    buffer_store_dwordx4 v[44:47], v2, s[32:35], s92 offen offset:1024 sc1
    buffer_store_dwordx4 v[48:51], v2, s[32:35], s91 offen offset:0 sc1
    buffer_store_dwordx4 v[52:55], v2, s[32:35], s91 offen offset:1024 sc1
    s_mov_b32 exec_lo, 0xffff0000
    s_mov_b32 exec_hi, 0
    v_mov_b32 v56, v60
    s_mov_b32 exec_lo, 0
    s_mov_b32 exec_hi, 0xffff
    v_mov_b32 v56, v64
    s_mov_b32 exec_hi, 0xffff0000
    v_mov_b32 v56, v68
    s_mov_b64 exec, -1
    s_lshr_b32 s59, s85, 3
    s_lshl_b32 s59, s59, 2
    s_add_u32 s59, s59, s37
    s_mul_i32 s59, s59, 14336
    s_lshl_b32 s3, s84, 8
    s_add_u32 s59, s59, s3
    s_add_u32 s59, s59, 14155776
    v_lshlrev_b32 v3, 2, v1
    buffer_store_dword v56, v3, s[32:35], s59 offen sc1
    s_waitcnt vmcnt(9)
    s_barrier
    s_add_u32 m0, s58, 98304
    s_nop 0
    buffer_load_dwordx4 v11, s[32:35], s57 offen offset:0 sc1 lds
    buffer_load_dwordx4 v11, s[32:35], s57 offen offset:1024 sc1 lds
    buffer_load_dwordx4 v11, s[32:35], s57 offen offset:2048 sc1 lds
    buffer_load_dwordx4 v11, s[32:35], s57 offen offset:3072 sc1 lds
    s_add_u32 s57, s57, 4096
    s_add_u32 m0, s58, 102400
    s_nop 0
    buffer_load_dwordx4 v11, s[32:35], s57 offen offset:0 sc1 lds
    buffer_load_dwordx4 v11, s[32:35], s57 offen offset:1024 sc1 lds
    buffer_load_dwordx4 v11, s[32:35], s57 offen offset:2048 sc1 lds
    buffer_load_dwordx4 v11, s[32:35], s57 offen offset:3072 sc1 lds
    s_add_u32 s57, s57, 28672
    s_waitcnt vmcnt(29)
    v_xor_b32 v77, 32, v38
    v_xor_b32 v78, 64, v38
    v_xor_b32 v79, 96, v38
    ds_read_b64 v[40:41], v38 offset:0
    ds_read_b64 v[42:43], v77 offset:0
    ds_read_b64 v[44:45], v38 offset:2048
    ds_read_b64 v[46:47], v77 offset:2048
    ds_read_b64 v[48:49], v78 offset:0
    ds_read_b64 v[50:51], v79 offset:0
    ds_read_b64 v[52:53], v78 offset:2048
    ds_read_b64 v[54:55], v79 offset:2048
    s_lshr_b32 s91, s60, 5
    s_add_u32 s91, s91, 32
    s_lshr_b32 s92, s91, 2
    s_lshl_b32 s92, s92, 19
    s_and_b32 s3, s91, 3
    s_lshl_b32 s3, s3, 11
    s_add_u32 s92, s92, s3
    s_and_b32 s3, s60, 31
    s_lshl_b32 s3, s3, 14
    s_add_u32 s92, s92, s3
    s_add_u32 s92, s92, 67108864
    s_add_u32 s91, s92, 8192
    s_waitcnt lgkmcnt(0)
    buffer_store_dwordx4 v[40:43], v2, s[32:35], s92 offen offset:0 sc1
    buffer_store_dwordx4 v[44:47], v2, s[32:35], s92 offen offset:1024 sc1
    buffer_store_dwordx4 v[48:51], v2, s[32:35], s91 offen offset:0 sc1
    buffer_store_dwordx4 v[52:55], v2, s[32:35], s91 offen offset:1024 sc1
    s_waitcnt vmcnt(4)
    s_barrier
    s_add_u32 m0, s58, 131072
    s_nop 0
    buffer_load_dwordx4 v11, s[32:35], s57 offen offset:0 sc1 lds
    buffer_load_dwordx4 v11, s[32:35], s57 offen offset:1024 sc1 lds
    buffer_load_dwordx4 v11, s[32:35], s57 offen offset:2048 sc1 lds
    buffer_load_dwordx4 v11, s[32:35], s57 offen offset:3072 sc1 lds
    s_add_u32 s57, s57, 4096
    s_add_u32 m0, s58, 135168
    s_nop 0
    buffer_load_dwordx4 v11, s[32:35], s57 offen offset:0 sc1 lds
    buffer_load_dwordx4 v11, s[32:35], s57 offen offset:1024 sc1 lds
    buffer_load_dwordx4 v11, s[32:35], s57 offen offset:2048 sc1 lds
    buffer_load_dwordx4 v11, s[32:35], s57 offen offset:3072 sc1 lds
    s_add_u32 s57, s57, 28672
    s_waitcnt vmcnt(25)
    v_xor_b32 v77, 32, v37
    v_xor_b32 v78, 64, v37
    v_xor_b32 v79, 96, v37
    ds_read_b64_tr_b16 v[40:41], v37 offset:4096
    ds_read_b64_tr_b16 v[42:43], v37 offset:6144
    ds_read_b64_tr_b16 v[44:45], v77 offset:4096
    ds_read_b64_tr_b16 v[46:47], v77 offset:6144
    ds_read_b64_tr_b16 v[48:49], v78 offset:4096
    ds_read_b64_tr_b16 v[50:51], v78 offset:6144
    ds_read_b64_tr_b16 v[52:53], v79 offset:4096
    ds_read_b64_tr_b16 v[54:55], v79 offset:6144
    s_and_b32 s92, s90, 15
    s_mul_i32 s92, s92, 229376
    s_lshr_b32 s3, s90, 4
    s_lshl_b32 s3, s3, 12
    s_add_u32 s92, s92, s3
    s_add_u32 s92, s92, 75497472
    s_waitcnt lgkmcnt(0)
    buffer_store_dwordx4 v[40:43], v2, s[32:35], s92 offen offset:0 sc1
    buffer_store_dwordx4 v[44:47], v2, s[32:35], s92 offen offset:1024 sc1
    buffer_store_dwordx4 v[48:51], v2, s[32:35], s92 offen offset:2048 sc1
    buffer_store_dwordx4 v[52:55], v2, s[32:35], s92 offen offset:3072 sc1
    s_lshr_b32 s59, s2, 3
    s_lshl_b32 s59, s59, 2
    s_add_u32 s59, s59, s37
    s_lshl_b32 s59, s59, 14
    s_lshl_b32 s3, s37, 8
    s_add_u32 m0, s3, 49152
    s_add_u32 s59, s59, 0
    s_add_u32 s3, s59, 8192
    buffer_load_dword v39, s[76:79], s59 offen lds
    buffer_load_dword v39, s[76:79], s3 offen lds
    s_waitcnt vmcnt(6)
    s_barrier
    s_getpc_b64 s[76:77]
L_pc_11:
    s_add_u32 s76, s76, sequential_preLN__grouped_kv_mqa__mixer_gmlp__prompt_kernel-L_pc_11
    s_addc_u32 s77, s77, -1
    s_mov_b32 s78, Lz_sequential_preLN__grouped_kv_mqa__mixer_gmlp__prompt_kernel-sequential_preLN__grouped_kv_mqa__mixer_gmlp__prompt_kernel
    s_mov_b32 s79, 0x20000
    s_lshr_b32 s3, s2, 3
    s_lshl_b32 s3, s3, 10
    v_and_b32 v3, 7, v1
    v_lshlrev_b32 v3, 7, v3
    v_lshrrev_b32 v76, 3, v1
    v_lshl_add_u32 v3, v76, 15, v3
    v_add_u32 v3, s3, v3
    buffer_load_dword v76, v3, s[76:79], 0 offen
    s_waitcnt vmcnt(0)
    s_barrier
    s_and_b32 s98, s2, 7
    s_lshr_b32 s96, s98, 1
    s_lshl_b32 s96, s96, 2
    s_and_b32 s97, s98, 1
    s_lshl_b32 s97, s97, 3
    s_lshr_b32 s99, s2, 6
    s_add_u32 s96, s96, s99
    s_lshr_b32 s98, s2, 3
    s_and_b32 s98, s98, 7
    s_add_u32 s97, s97, s98
    s_mov_b64 s[76:77], s[16:17]
    s_mov_b32 s78, 2097152
    s_lshl_b32 s59, s97, 7
    s_lshl_b32 s90, s96, 18
    s_add_u32 s90, s90, s59
    s_add_u32 m0, s41, 32768
    s_lshl_b32 s3, s37, 15
    v_add_u32 v3, s3, v34
    buffer_load_dwordx4 v5, s[48:51], s90 offen offset:0 lds
    buffer_load_dwordx4 v6, s[48:51], s90 offen offset:1024 lds
    buffer_load_dwordx4 v7, s[48:51], s90 offen offset:2048 lds
    buffer_load_dwordx4 v8, s[48:51], s90 offen offset:3072 lds
    v_add_u32 v4, 15360, v3
    s_add_u32 m0, s42, 32768
    s_mov_b32 s56, 10
L_ew_12:
    s_sub_u32 s56, s56, 1
    buffer_load_dwordx4 v3, s[76:79], s59 offen lds
    buffer_load_dwordx4 v4, s[76:79], s59 offen offset:1024 lds
    s_add_u32 s59, s59, 131072
    s_add_u32 m0, m0, 8192
    s_cmp_lg_u32 s56, 0
    s_nop 4
    s_cbranch_scc1 L_ew_12
    s_barrier
    v_mov_b32 v3, 0
    ds_read_b128 v[40:43], v3 offset:28672
    s_waitcnt lgkmcnt(0)
    v_or3_b32 v40, v40, v41, v42
    v_or_b32 v40, v40, v43
    s_nop 1
    v_readfirstlane_b32 s3, v40
    s_nop 3
    s_cmp_eq_u32 s3, 0
    s_cbranch_scc1 L_chain_entry
    s_waitcnt vmcnt(0)
    s_mov_b32 s57, 4194304
    s_add_u32 m0, s58, 98304
    s_nop 0
    buffer_load_dwordx4 v11, s[32:35], s57 offen offset:0 sc1 lds
    buffer_load_dwordx4 v11, s[32:35], s57 offen offset:1024 sc1 lds
    buffer_load_dwordx4 v11, s[32:35], s57 offen offset:2048 sc1 lds
    buffer_load_dwordx4 v11, s[32:35], s57 offen offset:3072 sc1 lds
    s_add_u32 s57, s57, 4096
    s_add_u32 m0, s58, 102400
    s_nop 0
    buffer_load_dwordx4 v11, s[32:35], s57 offen offset:0 sc1 lds
    buffer_load_dwordx4 v11, s[32:35], s57 offen offset:1024 sc1 lds
    buffer_load_dwordx4 v11, s[32:35], s57 offen offset:2048 sc1 lds
    buffer_load_dwordx4 v11, s[32:35], s57 offen offset:3072 sc1 lds
    s_add_u32 s57, s57, 28672
    s_add_u32 m0, s58, 131072
    s_nop 0
    buffer_load_dwordx4 v11, s[32:35], s57 offen offset:0 sc1 lds
    buffer_load_dwordx4 v11, s[32:35], s57 offen offset:1024 sc1 lds
    buffer_load_dwordx4 v11, s[32:35], s57 offen offset:2048 sc1 lds
    buffer_load_dwordx4 v11, s[32:35], s57 offen offset:3072 sc1 lds
    s_add_u32 s57, s57, 4096
    s_add_u32 m0, s58, 135168
    s_nop 0
    buffer_load_dwordx4 v11, s[32:35], s57 offen offset:0 sc1 lds
    buffer_load_dwordx4 v11, s[32:35], s57 offen offset:1024 sc1 lds
    buffer_load_dwordx4 v11, s[32:35], s57 offen offset:2048 sc1 lds
    buffer_load_dwordx4 v11, s[32:35], s57 offen offset:3072 sc1 lds
    s_add_u32 s57, s57, 28672
    s_waitcnt vmcnt(0)
    s_barrier
    s_mov_b32 s90, 65536
    s_mov_b32 s56, 8
L_rerun_13:
    s_waitcnt vmcnt(0)
    s_barrier
    s_add_u32 m0, s58, s90
    s_nop 0
    buffer_load_dwordx4 v11, s[32:35], s57 offen offset:0 sc1 lds
    buffer_load_dwordx4 v11, s[32:35], s57 offen offset:1024 sc1 lds
    buffer_load_dwordx4 v11, s[32:35], s57 offen offset:2048 sc1 lds
    buffer_load_dwordx4 v11, s[32:35], s57 offen offset:3072 sc1 lds
    s_add_u32 s57, s57, 4096
    s_add_u32 m0, m0, 4096
    s_nop 0
    buffer_load_dwordx4 v11, s[32:35], s57 offen offset:0 sc1 lds
    buffer_load_dwordx4 v11, s[32:35], s57 offen offset:1024 sc1 lds
    buffer_load_dwordx4 v11, s[32:35], s57 offen offset:2048 sc1 lds
    buffer_load_dwordx4 v11, s[32:35], s57 offen offset:3072 sc1 lds
    s_add_u32 s57, s57, 28672
    s_add_u32 s90, s90, 32768
    s_cmp_eq_u32 s90, 163840
    s_cselect_b32 s90, 65536, s90
    s_sub_u32 s56, s56, 1
    s_cmp_lg_u32 s56, 0
    s_cbranch_scc1 L_rerun_13
    s_waitcnt vmcnt(0)
    s_barrier
    s_and_b32 s98, s2, 7
    s_lshr_b32 s96, s98, 1
    s_lshl_b32 s96, s96, 2
    s_and_b32 s97, s98, 1
    s_lshl_b32 s97, s97, 3
    s_lshr_b32 s99, s2, 6
    s_add_u32 s96, s96, s99
    s_lshr_b32 s98, s2, 3
    s_and_b32 s98, s98, 7
    s_add_u32 s97, s97, s98
    s_mov_b64 s[76:77], s[16:17]
    s_mov_b32 s78, 2097152
    s_lshl_b32 s59, s97, 7
    s_lshl_b32 s90, s96, 18
    s_add_u32 s90, s90, s59
    s_add_u32 m0, s41, 32768
    s_lshl_b32 s3, s37, 15
    v_add_u32 v3, s3, v34
    buffer_load_dwordx4 v5, s[48:51], s90 offen offset:0 lds
    buffer_load_dwordx4 v6, s[48:51], s90 offen offset:1024 lds
    buffer_load_dwordx4 v7, s[48:51], s90 offen offset:2048 lds
    buffer_load_dwordx4 v8, s[48:51], s90 offen offset:3072 lds
    v_add_u32 v4, 15360, v3
    s_add_u32 m0, s42, 32768
    s_mov_b32 s56, 10
L_ew_14:
    s_sub_u32 s56, s56, 1
    buffer_load_dwordx4 v3, s[76:79], s59 offen lds
    buffer_load_dwordx4 v4, s[76:79], s59 offen offset:1024 lds
    s_add_u32 s59, s59, 131072
    s_add_u32 m0, m0, 8192
    s_cmp_lg_u32 s56, 0
    s_nop 4
    s_cbranch_scc1 L_ew_14
    s_branch L_chain_entry
L_comp_8:
    v_and_b32 v11, 15, v1
    v_lshlrev_b32 v11, 4, v11
    v_lshrrev_b32 v3, 5, v1
    v_lshl_add_u32 v11, v3, 8, v11
    v_bfe_u32 v3, v1, 4, 1
    v_lshl_add_u32 v11, v3, 10, v11
    s_lshl_b32 s3, s24, 11
    v_add_u32 v11, s3, v11
    v_and_b32 v13, 31, v1
    v_bfe_u32 v3, v1, 1, 3
    v_lshrrev_b32 v4, 5, v1
    v_xor_b32 v3, v3, v4
    v_lshlrev_b32 v13, 7, v13
    v_lshl_add_u32 v13, v3, 4, v13
    s_lshl_b32 s3, s24, 12
    v_add_u32 v13, s3, v13
    v_bfe_u32 v3, v1, 2, 2
    v_lshl_add_u32 v3, v4, 3, v3
    v_lshlrev_b32 v12, 7, v3
    v_and_b32 v3, 3, v1
    v_lshl_add_u32 v12, v3, 3, v12
    v_bfe_u32 v3, v1, 4, 1
    v_lshl_add_u32 v12, v3, 5, v12
    v_bfe_u32 v3, v1, 3, 1
    v_lshl_add_u32 v12, v3, 6, v12
    v_add_u32 v12, 16384, v12
    s_mov_b32 s56, 0
    s_lshl_b32 s62, s25, 18
    s_lshl_b32 s3, s26, 14
    s_add_u32 s62, s62, s3
    s_add_u32 s62, s62, 5242880
    s_add_u32 s63, s62, 8192
    v_mov_b32 v92, 0
    v_mov_b32 v93, 0
    v_mov_b32 v94, 0
    v_mov_b32 v95, 0
    v_mov_b32 v96, 0
    v_mov_b32 v97, 0
    v_mov_b32 v98, 0
    v_mov_b32 v99, 0
    v_mov_b32 v100, 0
    v_mov_b32 v101, 0
    v_mov_b32 v102, 0
    v_mov_b32 v103, 0
    v_mov_b32 v104, 0
    v_mov_b32 v105, 0
    v_mov_b32 v106, 0
    v_mov_b32 v107, 0
    v_mov_b32 v108, 0
    v_mov_b32 v109, 0
    v_mov_b32 v110, 0
    v_mov_b32 v111, 0
    v_mov_b32 v112, 0
    v_mov_b32 v113, 0
    v_mov_b32 v114, 0
    v_mov_b32 v115, 0
    v_mov_b32 v116, 0
    v_mov_b32 v117, 0
    v_mov_b32 v118, 0
    v_mov_b32 v119, 0
    v_mov_b32 v120, 0
    v_mov_b32 v121, 0
    v_mov_b32 v122, 0
    v_mov_b32 v123, 0
    v_bfe_u32 v3, v1, 2, 1
    v_mul_u32_u24 v3, 0x3f80, v3
    v_lshl_or_b32 v158, v3, 16, v3
    v_mov_b32 v159, v158
    v_xor_b32 v156, 0x3f803f80, v158
    v_mov_b32 v157, v156
    v_and_b32 v3, 1, v1
    v_mul_u32_u24 v3, 0xaaaa, v3
    v_add_u32 v22, 0x4444, v3
    s_mov_b64 s[52:53], s[14:15]
    s_cmp_eq_u32 s24, 3
    s_cselect_b32 s54, 4, 0
    v_mov_b32 v3, 0
    buffer_load_dword v21, v3, s[52:55], 0 offen sc1
    v_add_u32 v16, s56, v13
    v_add_u32 v14, s56, v12
    v_xor_b32 v15, 64, v14
    v_xor_b32 v17, 32, v16
    v_xor_b32 v18, 64, v16
    v_xor_b32 v19, 96, v16
    s_add_u32 s56, s56, 24576
    s_cmp_eq_u32 s56, 98304
    s_cselect_b32 s56, 0, s56
    ds_read_b128 v[28:31], v16
    ds_read_b64_tr_b16 v[44:45], v14 offset:0
    ds_read_b64_tr_b16 v[46:47], v14 offset:512
    ds_read_b64_tr_b16 v[48:49], v15 offset:0
    ds_read_b64_tr_b16 v[50:51], v15 offset:512
    ds_read_b128 v[32:35], v17
    ds_read_b64_tr_b16 v[52:53], v14 offset:2048
    ds_read_b64_tr_b16 v[54:55], v14 offset:2560
    ds_read_b64_tr_b16 v[56:57], v15 offset:2048
    ds_read_b64_tr_b16 v[58:59], v15 offset:2560
    ds_read_b128 v[36:39], v18
    ds_read_b64_tr_b16 v[60:61], v14 offset:4096
    ds_read_b64_tr_b16 v[62:63], v14 offset:4608
    ds_read_b64_tr_b16 v[64:65], v15 offset:4096
    ds_read_b64_tr_b16 v[66:67], v15 offset:4608
    ds_read_b128 v[40:43], v19
    ds_read_b64_tr_b16 v[68:69], v14 offset:6144
    ds_read_b64_tr_b16 v[70:71], v14 offset:6656
    ds_read_b64_tr_b16 v[72:73], v15 offset:6144
    ds_read_b64_tr_b16 v[74:75], v15 offset:6656
    s_cmp_lg_u32 s24, 2
    s_cbranch_scc1 L_cs_16
    v_mov_b32 v23, 0
    v_mov_b32 v24, 0
    v_mov_b32 v4, 0x3f803f80
    s_lshl_b32 s3, s25, 4
    s_add_u32 s3, s3, s26
    s_lshl_b32 s3, s3, 8
    s_add_u32 s3, s3, 4784128
    s_waitcnt lgkmcnt(0)
    v_dot2c_f32_bf16 v23, v44, v4
    v_dot2c_f32_bf16 v24, v48, v4
    v_dot2c_f32_bf16 v23, v45, v4
    v_dot2c_f32_bf16 v24, v49, v4
    v_dot2c_f32_bf16 v23, v46, v4
    v_dot2c_f32_bf16 v24, v50, v4
    v_dot2c_f32_bf16 v23, v47, v4
    v_dot2c_f32_bf16 v24, v51, v4
    v_dot2c_f32_bf16 v23, v52, v4
    v_dot2c_f32_bf16 v24, v56, v4
    v_dot2c_f32_bf16 v23, v53, v4
    v_dot2c_f32_bf16 v24, v57, v4
    v_dot2c_f32_bf16 v23, v54, v4
    v_dot2c_f32_bf16 v24, v58, v4
    v_dot2c_f32_bf16 v23, v55, v4
    v_dot2c_f32_bf16 v24, v59, v4
    v_dot2c_f32_bf16 v23, v60, v4
    v_dot2c_f32_bf16 v24, v64, v4
    v_dot2c_f32_bf16 v23, v61, v4
    v_dot2c_f32_bf16 v24, v65, v4
    v_dot2c_f32_bf16 v23, v62, v4
    v_dot2c_f32_bf16 v24, v66, v4
    v_dot2c_f32_bf16 v23, v63, v4
    v_dot2c_f32_bf16 v24, v67, v4
    v_dot2c_f32_bf16 v23, v68, v4
    v_dot2c_f32_bf16 v24, v72, v4
    v_dot2c_f32_bf16 v23, v69, v4
    v_dot2c_f32_bf16 v24, v73, v4
    v_dot2c_f32_bf16 v23, v70, v4
    v_dot2c_f32_bf16 v24, v74, v4
    v_dot2c_f32_bf16 v23, v71, v4
    v_dot2c_f32_bf16 v24, v75, v4
    v_lshlrev_b32 v3, 2, v1
    s_nop 2
    v_permlane32_swap_b32 v23, v24
    s_nop 1
    v_add_f32 v23, v23, v24
    buffer_store_dword v23, v3, s[32:35], s3 offen sc1
L_cs_16:
    s_mov_b32 s57, 7
L_qloop_15:
    v_add_u32 v16, s56, v13
    v_add_u32 v14, s56, v12
    v_xor_b32 v15, 64, v14
    v_xor_b32 v17, 32, v16
    v_xor_b32 v18, 64, v16
    v_xor_b32 v19, 96, v16
    s_add_u32 s56, s56, 24576
    s_cmp_eq_u32 s56, 98304
    s_cselect_b32 s56, 0, s56
    s_waitcnt lgkmcnt(0)
    s_barrier
    v_mfma_f32_32x32x16_bf16 v[92:107], v[44:47], v[28:31], v[92:107]
    ds_read_b128 v[76:79], v16
    ds_read_b64_tr_b16 v[176:177], v14 offset:0
    ds_read_b64_tr_b16 v[178:179], v14 offset:512
    ds_read_b64_tr_b16 v[180:181], v15 offset:0
    v_mfma_f32_32x32x16_bf16 v[108:123], v[48:51], v[28:31], v[108:123]
    ds_read_b64_tr_b16 v[182:183], v15 offset:512
    ds_read_b128 v[80:83], v17
    ds_read_b64_tr_b16 v[184:185], v14 offset:2048
    v_mfma_f32_32x32x16_bf16 v[92:107], v[52:55], v[32:35], v[92:107]
    ds_read_b64_tr_b16 v[186:187], v14 offset:2560
    ds_read_b64_tr_b16 v[188:189], v15 offset:2048
    ds_read_b64_tr_b16 v[190:191], v15 offset:2560
    v_mfma_f32_32x32x16_bf16 v[108:123], v[56:59], v[32:35], v[108:123]
    ds_read_b128 v[84:87], v18
    ds_read_b64_tr_b16 v[192:193], v14 offset:4096
    ds_read_b64_tr_b16 v[194:195], v14 offset:4608
    ds_read_b64_tr_b16 v[196:197], v15 offset:4096
    v_mfma_f32_32x32x16_bf16 v[92:107], v[60:63], v[36:39], v[92:107]
    ds_read_b64_tr_b16 v[198:199], v15 offset:4608
    ds_read_b128 v[88:91], v19
    ds_read_b64_tr_b16 v[200:201], v14 offset:6144
    v_mfma_f32_32x32x16_bf16 v[108:123], v[64:67], v[36:39], v[108:123]
    ds_read_b64_tr_b16 v[202:203], v14 offset:6656
    ds_read_b64_tr_b16 v[204:205], v15 offset:6144
    ds_read_b64_tr_b16 v[206:207], v15 offset:6656
    v_mfma_f32_32x32x16_bf16 v[92:107], v[68:71], v[40:43], v[92:107]
    v_mfma_f32_32x32x16_bf16 v[108:123], v[72:75], v[40:43], v[108:123]
    v_add_u32 v16, s56, v13
    v_add_u32 v14, s56, v12
    v_xor_b32 v15, 64, v14
    v_xor_b32 v17, 32, v16
    v_xor_b32 v18, 64, v16
    v_xor_b32 v19, 96, v16
    s_add_u32 s56, s56, 24576
    s_cmp_eq_u32 s56, 98304
    s_cselect_b32 s56, 0, s56
    s_cmp_eq_u32 s57, 6
    s_cbranch_scc1 L_sig_17
    s_sub_u32 s57, s57, 1
    s_cmp_lg_u32 s57, 0
    s_waitcnt lgkmcnt(0)
    s_barrier
L_sigb_18:
    v_mfma_f32_32x32x16_bf16 v[92:107], v[176:179], v[76:79], v[92:107]
    ds_read_b128 v[28:31], v16
    ds_read_b64_tr_b16 v[44:45], v14 offset:0
    ds_read_b64_tr_b16 v[46:47], v14 offset:512
    ds_read_b64_tr_b16 v[48:49], v15 offset:0
    v_mfma_f32_32x32x16_bf16 v[108:123], v[180:183], v[76:79], v[108:123]
    ds_read_b64_tr_b16 v[50:51], v15 offset:512
    ds_read_b128 v[32:35], v17
    ds_read_b64_tr_b16 v[52:53], v14 offset:2048
    v_mfma_f32_32x32x16_bf16 v[92:107], v[184:187], v[80:83], v[92:107]
    ds_read_b64_tr_b16 v[54:55], v14 offset:2560
    ds_read_b64_tr_b16 v[56:57], v15 offset:2048
    ds_read_b64_tr_b16 v[58:59], v15 offset:2560
    v_mfma_f32_32x32x16_bf16 v[108:123], v[188:191], v[80:83], v[108:123]
    ds_read_b128 v[36:39], v18
    ds_read_b64_tr_b16 v[60:61], v14 offset:4096
    ds_read_b64_tr_b16 v[62:63], v14 offset:4608
    ds_read_b64_tr_b16 v[64:65], v15 offset:4096
    v_mfma_f32_32x32x16_bf16 v[92:107], v[192:195], v[84:87], v[92:107]
    ds_read_b64_tr_b16 v[66:67], v15 offset:4608
    ds_read_b128 v[40:43], v19
    ds_read_b64_tr_b16 v[68:69], v14 offset:6144
    v_mfma_f32_32x32x16_bf16 v[108:123], v[196:199], v[84:87], v[108:123]
    ds_read_b64_tr_b16 v[70:71], v14 offset:6656
    ds_read_b64_tr_b16 v[72:73], v15 offset:6144
    ds_read_b64_tr_b16 v[74:75], v15 offset:6656
    v_mfma_f32_32x32x16_bf16 v[92:107], v[200:203], v[88:91], v[92:107]
    v_mfma_f32_32x32x16_bf16 v[108:123], v[204:207], v[88:91], v[108:123]
    s_cbranch_scc1 L_qloop_15
    v_add_u32 v16, s56, v13
    v_add_u32 v14, s56, v12
    v_xor_b32 v15, 64, v14
    v_xor_b32 v17, 32, v16
    v_xor_b32 v18, 64, v16
    v_xor_b32 v19, 96, v16
    s_add_u32 s56, s56, 24576
    s_cmp_eq_u32 s56, 98304
    s_cselect_b32 s56, 0, s56
    s_waitcnt lgkmcnt(0)
    s_barrier
    v_mfma_f32_32x32x16_bf16 v[92:107], v[44:47], v[28:31], v[92:107]
    ds_read_b128 v[76:79], v16
    ds_read_b64_tr_b16 v[176:177], v14 offset:0
    ds_read_b64_tr_b16 v[178:179], v14 offset:512
    ds_read_b64_tr_b16 v[180:181], v15 offset:0
    v_mfma_f32_32x32x16_bf16 v[108:123], v[48:51], v[28:31], v[108:123]
    ds_read_b64_tr_b16 v[182:183], v15 offset:512
    ds_read_b128 v[80:83], v17
    ds_read_b64_tr_b16 v[184:185], v14 offset:2048
    v_mfma_f32_32x32x16_bf16 v[92:107], v[52:55], v[32:35], v[92:107]
    ds_read_b64_tr_b16 v[186:187], v14 offset:2560
    ds_read_b64_tr_b16 v[188:189], v15 offset:2048
    ds_read_b64_tr_b16 v[190:191], v15 offset:2560
    v_mfma_f32_32x32x16_bf16 v[108:123], v[56:59], v[32:35], v[108:123]
    ds_read_b128 v[84:87], v18
    ds_read_b64_tr_b16 v[192:193], v14 offset:4096
    ds_read_b64_tr_b16 v[194:195], v14 offset:4608
    ds_read_b64_tr_b16 v[196:197], v15 offset:4096
    v_mfma_f32_32x32x16_bf16 v[92:107], v[60:63], v[36:39], v[92:107]
    ds_read_b64_tr_b16 v[198:199], v15 offset:4608
    ds_read_b128 v[88:91], v19
    ds_read_b64_tr_b16 v[200:201], v14 offset:6144
    v_mfma_f32_32x32x16_bf16 v[108:123], v[64:67], v[36:39], v[108:123]
    ds_read_b64_tr_b16 v[202:203], v14 offset:6656
    ds_read_b64_tr_b16 v[204:205], v15 offset:6144
    ds_read_b64_tr_b16 v[206:207], v15 offset:6656
    v_mfma_f32_32x32x16_bf16 v[92:107], v[68:71], v[40:43], v[92:107]
    v_mfma_f32_32x32x16_bf16 v[108:123], v[72:75], v[40:43], v[108:123]
    s_waitcnt lgkmcnt(0)
    v_mfma_f32_32x32x16_bf16 v[92:107], v[176:179], v[76:79], v[92:107]
    v_mfma_f32_32x32x16_bf16 v[108:123], v[180:183], v[76:79], v[108:123]
    v_mfma_f32_32x32x16_bf16 v[92:107], v[184:187], v[80:83], v[92:107]
    v_mfma_f32_32x32x16_bf16 v[108:123], v[188:191], v[80:83], v[108:123]
    v_mfma_f32_32x32x16_bf16 v[92:107], v[192:195], v[84:87], v[92:107]
    v_mfma_f32_32x32x16_bf16 v[108:123], v[196:199], v[84:87], v[108:123]
    v_mfma_f32_32x32x16_bf16 v[92:107], v[200:203], v[88:91], v[92:107]
    v_mfma_f32_32x32x16_bf16 v[108:123], v[204:207], v[88:91], v[108:123]
    v_add_u32 v20, 98304, v2
    v_lshrrev_b32 v3, 5, v1
    v_lshlrev_b32 v3, 4, v3
    v_and_b32 v4, 31, v1
    s_lshl_b32 s3, s24, 8
    v_lshl_add_u32 v4, v4, 3, s3
    s_barrier
    ds_read_b64 v[168:169], v4 offset:8448
    ds_read_b128 v[28:31], v3 offset:8192
    ds_read_b128 v[32:35], v3 offset:8224
    ds_read_b128 v[36:39], v3 offset:8256
    ds_read_b128 v[40:43], v3 offset:8288
    ds_read_b128 v[44:47], v3 offset:8320
    ds_read_b128 v[48:51], v3 offset:8352
    ds_read_b128 v[52:55], v3 offset:8384
    ds_read_b128 v[56:59], v3 offset:8416
    ds_read_b128 v[160:163], v20
    ds_read_b128 v[164:167], v20 offset:1024
    s_waitcnt lgkmcnt(2)
    v_mul_f32 v168, 0x3e8293ee, v168
    v_mul_f32 v169, 0x3e8293ee, v169
    v_pk_mul_f32 v[28:29], v[28:29], v[168:169] op_sel:[0,1] op_sel_hi:[1,1]
    v_pk_mul_f32 v[30:31], v[30:31], v[168:169] op_sel:[0,1] op_sel_hi:[1,1]
    v_pk_mul_f32 v[32:33], v[32:33], v[168:169] op_sel:[0,1] op_sel_hi:[1,1]
    v_pk_mul_f32 v[34:35], v[34:35], v[168:169] op_sel:[0,1] op_sel_hi:[1,1]
    v_pk_mul_f32 v[36:37], v[36:37], v[168:169] op_sel:[0,1] op_sel_hi:[1,1]
    v_pk_mul_f32 v[38:39], v[38:39], v[168:169] op_sel:[0,1] op_sel_hi:[1,1]
    v_pk_mul_f32 v[40:41], v[40:41], v[168:169] op_sel:[0,1] op_sel_hi:[1,1]
    v_pk_mul_f32 v[42:43], v[42:43], v[168:169] op_sel:[0,1] op_sel_hi:[1,1]
    v_pk_fma_f32 v[92:93], v[92:93], v[168:169], v[28:29] op_sel_hi:[1,0,1]
    v_pk_fma_f32 v[94:95], v[94:95], v[168:169], v[30:31] op_sel_hi:[1,0,1]
    v_pk_fma_f32 v[96:97], v[96:97], v[168:169], v[32:33] op_sel_hi:[1,0,1]
    v_pk_fma_f32 v[98:99], v[98:99], v[168:169], v[34:35] op_sel_hi:[1,0,1]
    v_pk_fma_f32 v[100:101], v[100:101], v[168:169], v[36:37] op_sel_hi:[1,0,1]
    v_pk_fma_f32 v[102:103], v[102:103], v[168:169], v[38:39] op_sel_hi:[1,0,1]
    v_pk_fma_f32 v[104:105], v[104:105], v[168:169], v[40:41] op_sel_hi:[1,0,1]
    v_pk_fma_f32 v[106:107], v[106:107], v[168:169], v[42:43] op_sel_hi:[1,0,1]
    v_cvt_pk_bf16_f32 v124, v92, v93
    v_cvt_pk_bf16_f32 v125, v94, v95
    v_cvt_pk_bf16_f32 v126, v96, v97
    v_cvt_pk_bf16_f32 v127, v98, v99
    v_cvt_pk_bf16_f32 v128, v100, v101
    v_cvt_pk_bf16_f32 v129, v102, v103
    v_cvt_pk_bf16_f32 v130, v104, v105
    v_cvt_pk_bf16_f32 v131, v106, v107
    s_waitcnt lgkmcnt(0)
    s_nop 0
    v_mfma_f32_32x32x16_bf16 v[28:43], v[160:163], v[124:127], 0
    v_mfma_f32_32x32x16_bf16 v[28:43], v[164:167], v[128:131], v[28:43]
    v_pk_mul_f32 v[44:45], v[44:45], v[168:169] op_sel:[0,1] op_sel_hi:[1,1]
    v_pk_mul_f32 v[46:47], v[46:47], v[168:169] op_sel:[0,1] op_sel_hi:[1,1]
    v_pk_mul_f32 v[48:49], v[48:49], v[168:169] op_sel:[0,1] op_sel_hi:[1,1]
    v_pk_mul_f32 v[50:51], v[50:51], v[168:169] op_sel:[0,1] op_sel_hi:[1,1]
    v_pk_mul_f32 v[52:53], v[52:53], v[168:169] op_sel:[0,1] op_sel_hi:[1,1]
    v_pk_mul_f32 v[54:55], v[54:55], v[168:169] op_sel:[0,1] op_sel_hi:[1,1]
    v_pk_mul_f32 v[56:57], v[56:57], v[168:169] op_sel:[0,1] op_sel_hi:[1,1]
    v_pk_mul_f32 v[58:59], v[58:59], v[168:169] op_sel:[0,1] op_sel_hi:[1,1]
    v_pk_fma_f32 v[108:109], v[108:109], v[168:169], v[44:45] op_sel_hi:[1,0,1]
    v_pk_fma_f32 v[110:111], v[110:111], v[168:169], v[46:47] op_sel_hi:[1,0,1]
    v_pk_fma_f32 v[112:113], v[112:113], v[168:169], v[48:49] op_sel_hi:[1,0,1]
    v_pk_fma_f32 v[114:115], v[114:115], v[168:169], v[50:51] op_sel_hi:[1,0,1]
    v_pk_fma_f32 v[116:117], v[116:117], v[168:169], v[52:53] op_sel_hi:[1,0,1]
    v_pk_fma_f32 v[118:119], v[118:119], v[168:169], v[54:55] op_sel_hi:[1,0,1]
    v_pk_fma_f32 v[120:121], v[120:121], v[168:169], v[56:57] op_sel_hi:[1,0,1]
    v_pk_fma_f32 v[122:123], v[122:123], v[168:169], v[58:59] op_sel_hi:[1,0,1]
    v_cvt_pk_bf16_f32 v132, v108, v109
    v_cvt_pk_bf16_f32 v133, v110, v111
    v_cvt_pk_bf16_f32 v134, v112, v113
    v_cvt_pk_bf16_f32 v135, v114, v115
    v_cvt_pk_bf16_f32 v136, v116, v117
    v_cvt_pk_bf16_f32 v137, v118, v119
    v_cvt_pk_bf16_f32 v138, v120, v121
    v_cvt_pk_bf16_f32 v139, v122, v123
    s_waitcnt lgkmcnt(0)
    s_nop 0
    v_mfma_f32_32x32x16_bf16 v[44:59], v[160:163], v[132:135], 0
    v_mfma_f32_32x32x16_bf16 v[44:59], v[164:167], v[136:139], v[44:59]
    v_max_f32 v23, v28, v29
    v_max3_f32 v23, v23, v30, v31
    v_max3_f32 v23, v23, v32, v33
    v_max3_f32 v23, v23, v34, v35
    v_max3_f32 v23, v23, v36, v37
    v_max3_f32 v23, v23, v38, v39
    v_max3_f32 v23, v23, v40, v41
    v_max3_f32 v23, v23, v42, v43
    s_nop 7
    v_max_f32 v24, v44, v45
    v_max3_f32 v24, v24, v46, v47
    v_max3_f32 v24, v24, v48, v49
    v_max3_f32 v24, v24, v50, v51
    v_max3_f32 v24, v24, v52, v53
    v_max3_f32 v24, v24, v54, v55
    v_max3_f32 v24, v24, v56, v57
    v_max3_f32 v24, v24, v58, v59
L_bstart_19:
    v_mov_b32 v3, v23
    v_mov_b32 v4, v24
    s_nop 1
    v_permlane32_swap_b32 v23, v3
    v_permlane32_swap_b32 v24, v4
    s_nop 1
    v_max_f32 v23, v23, v3
    v_max_f32 v24, v24, v4
    v_sub_f32 v60, 0, v23
    v_sub_f32 v61, 0, v23
    v_sub_f32 v62, 0, v23
    v_sub_f32 v63, 0, v23
    v_sub_f32 v64, 0, v23
    v_sub_f32 v65, 0, v23
    v_sub_f32 v66, 0, v23
    v_sub_f32 v67, 0, v23
    v_sub_f32 v68, 0, v23
    v_sub_f32 v69, 0, v23
    v_sub_f32 v70, 0, v23
    v_sub_f32 v71, 0, v23
    v_sub_f32 v72, 0, v23
    v_sub_f32 v73, 0, v23
    v_sub_f32 v74, 0, v23
    v_sub_f32 v75, 0, v23
    v_sub_f32 v76, 0, v24
    v_sub_f32 v77, 0, v24
    v_sub_f32 v78, 0, v24
    v_sub_f32 v79, 0, v24
    v_sub_f32 v80, 0, v24
    v_sub_f32 v81, 0, v24
    v_sub_f32 v82, 0, v24
    v_sub_f32 v83, 0, v24
    v_sub_f32 v84, 0, v24
    v_sub_f32 v85, 0, v24
    v_sub_f32 v86, 0, v24
    v_sub_f32 v87, 0, v24
    v_sub_f32 v88, 0, v24
    v_sub_f32 v89, 0, v24
    v_sub_f32 v90, 0, v24
    v_sub_f32 v91, 0, v24
    v_add_u32 v21, 131072, v2
    s_mov_b32 s59, 65536
    s_mov_b32 s58, 0
    v_mfma_f32_32x32x16_bf16 v[28:43], v[160:163], v[124:127], v[60:75]
    v_mfma_f32_32x32x16_bf16 v[28:43], v[164:167], v[128:131], v[28:43]
    ds_read_b128 v[168:171], v20 offset:2048
    v_mov_b32 v92, 0
    v_mov_b32 v93, 0
    v_mov_b32 v94, 0
    v_mov_b32 v95, 0
    v_mov_b32 v96, 0
    v_mov_b32 v97, 0
    v_mov_b32 v98, 0
    v_mov_b32 v99, 0
    v_mov_b32 v100, 0
    v_mov_b32 v101, 0
    v_mov_b32 v102, 0
    v_mov_b32 v103, 0
    v_mov_b32 v104, 0
    v_mov_b32 v105, 0
    v_mov_b32 v106, 0
    v_mov_b32 v107, 0
    v_mov_b32 v108, 0
    v_mov_b32 v109, 0
    v_mov_b32 v110, 0
    v_mov_b32 v111, 0
    v_mov_b32 v112, 0
    v_mov_b32 v113, 0
    v_mov_b32 v114, 0
    v_mov_b32 v115, 0
    v_mov_b32 v116, 0
    v_mov_b32 v117, 0
    v_mov_b32 v118, 0
    v_mov_b32 v119, 0
    v_mov_b32 v120, 0
    v_mov_b32 v121, 0
    v_mov_b32 v122, 0
    v_mov_b32 v123, 0
    v_mov_b32 v148, 0
    v_mov_b32 v152, 0
    v_mov_b32 v140, 0
    v_mov_b32 v144, 0
    v_mov_b32 v172, 0
    v_mov_b32 v149, 0
    v_mov_b32 v153, 0
    v_mov_b32 v141, 0
    v_mov_b32 v145, 0
    v_mov_b32 v173, 0
    v_mov_b32 v150, 0
    v_mov_b32 v154, 0
    v_mov_b32 v142, 0
    v_mov_b32 v146, 0
    v_mov_b32 v174, 0
    v_mov_b32 v151, 0
    v_mov_b32 v155, 0
    v_mov_b32 v143, 0
    v_mov_b32 v147, 0
    v_mov_b32 v175, 0
    s_waitcnt lgkmcnt(0)
    s_mov_b32 s64, 0x07060302
    s_setprio 3
    .p2align 3
L_bloop_21:
    v_mfma_f32_32x32x16_bf16 v[44:59], v[160:163], v[132:135], v[76:91]
    ds_read_b128 v[160:163], v20 offset:4096
    v_exp_f32 v28, v28
    v_exp_f32 v29, v29
    v_exp_f32 v30, v30
    v_smfmac_f32_16x16x64_bf16 v[152:155], v[156:159], v[140:147], v22
    v_exp_f32 v31, v31
    v_mfma_f32_32x32x16_bf16 v[108:123], v[172:175], v[144:147], v[108:123]
    ds_read_b128 v[172:175], v20 offset:3072
    v_cvt_pk_bf16_f32 v140, v28, v29
    v_exp_f32 v32, v32
    v_cvt_pk_bf16_f32 v141, v30, v31
    v_exp_f32 v33, v33
    v_mfma_f32_32x32x16_bf16 v[44:59], v[164:167], v[136:139], v[44:59]
    ds_read_b128 v[164:167], v20 offset:5120
    v_exp_f32 v34, v34
    v_cvt_pk_bf16_f32 v142, v32, v33
    v_exp_f32 v35, v35
    v_exp_f32 v36, v36
    v_cvt_pk_bf16_f32 v143, v34, v35
    v_exp_f32 v37, v37
    v_exp_f32 v38, v38
    s_waitcnt lgkmcnt(3)
    v_mfma_f32_32x32x16_bf16 v[92:107], v[168:171], v[140:143], v[92:107]
    v_exp_f32 v39, v39
    v_cvt_pk_bf16_f32 v144, v36, v37
    v_exp_f32 v40, v40
    v_cvt_pk_bf16_f32 v145, v38, v39
    v_exp_f32 v41, v41
    v_exp_f32 v42, v42
    v_exp_f32 v43, v43
    v_cvt_pk_bf16_f32 v146, v40, v41
    v_cvt_pk_bf16_f32 v147, v42, v43
    s_waitcnt lgkmcnt(0)
    v_mfma_f32_32x32x16_bf16 v[28:43], v[160:163], v[124:127], v[60:75]
    v_exp_f32 v44, v44
    v_exp_f32 v45, v45
    v_exp_f32 v46, v46
    v_smfmac_f32_16x16x64_bf16 v[148:151], v[156:159], v[140:147], v22
    v_exp_f32 v47, v47
    v_mfma_f32_32x32x16_bf16 v[92:107], v[172:175], v[144:147], v[92:107]
    v_cvt_pk_bf16_f32 v140, v44, v45
    v_exp_f32 v48, v48
    v_cvt_pk_bf16_f32 v141, v46, v47
    v_exp_f32 v49, v49
    v_mfma_f32_32x32x16_bf16 v[28:43], v[164:167], v[128:131], v[28:43]
    v_exp_f32 v50, v50
    v_cvt_pk_bf16_f32 v142, v48, v49
    v_exp_f32 v51, v51
    v_exp_f32 v52, v52
    v_cvt_pk_bf16_f32 v143, v50, v51
    v_exp_f32 v53, v53
    v_exp_f32 v54, v54
    v_mfma_f32_32x32x16_bf16 v[108:123], v[168:171], v[140:143], v[108:123]
    ds_read_b128 v[168:171], v20 offset:6144
    v_exp_f32 v55, v55
    v_cvt_pk_bf16_f32 v144, v52, v53
    v_exp_f32 v56, v56
    v_cvt_pk_bf16_f32 v145, v54, v55
    v_exp_f32 v57, v57
    v_exp_f32 v58, v58
    v_exp_f32 v59, v59
    v_cvt_pk_bf16_f32 v146, v56, v57
    v_cvt_pk_bf16_f32 v147, v58, v59
    v_mfma_f32_32x32x16_bf16 v[44:59], v[160:163], v[132:135], v[76:91]
    ds_read_b128 v[160:163], v20 offset:8192
    v_exp_f32 v28, v28
    v_exp_f32 v29, v29
    v_exp_f32 v30, v30
    v_smfmac_f32_16x16x64_bf16 v[152:155], v[156:159], v[140:147], v22
    v_exp_f32 v31, v31
    v_mfma_f32_32x32x16_bf16 v[108:123], v[172:175], v[144:147], v[108:123]
    ds_read_b128 v[172:175], v20 offset:7168
    v_cvt_pk_bf16_f32 v140, v28, v29
    v_exp_f32 v32, v32
    v_cvt_pk_bf16_f32 v141, v30, v31
    v_exp_f32 v33, v33
    v_mfma_f32_32x32x16_bf16 v[44:59], v[164:167], v[136:139], v[44:59]
    ds_read_b128 v[164:167], v20 offset:9216
    v_exp_f32 v34, v34
    v_cvt_pk_bf16_f32 v142, v32, v33
    v_exp_f32 v35, v35
    v_exp_f32 v36, v36
    v_cvt_pk_bf16_f32 v143, v34, v35
    v_exp_f32 v37, v37
    v_exp_f32 v38, v38
    s_waitcnt lgkmcnt(3)
    v_mfma_f32_32x32x16_bf16 v[92:107], v[168:171], v[140:143], v[92:107]
    v_exp_f32 v39, v39
    v_cvt_pk_bf16_f32 v144, v36, v37
    v_exp_f32 v40, v40
    v_cvt_pk_bf16_f32 v145, v38, v39
    v_exp_f32 v41, v41
    v_exp_f32 v42, v42
    v_exp_f32 v43, v43
    v_cvt_pk_bf16_f32 v146, v40, v41
    v_cvt_pk_bf16_f32 v147, v42, v43
    s_waitcnt lgkmcnt(0)
    v_mfma_f32_32x32x16_bf16 v[28:43], v[160:163], v[124:127], v[60:75]
    v_exp_f32 v44, v44
    v_exp_f32 v45, v45
    v_exp_f32 v46, v46
    v_smfmac_f32_16x16x64_bf16 v[148:151], v[156:159], v[140:147], v22
    v_exp_f32 v47, v47
    v_mfma_f32_32x32x16_bf16 v[92:107], v[172:175], v[144:147], v[92:107]
    v_cvt_pk_bf16_f32 v140, v44, v45
    v_exp_f32 v48, v48
    v_cvt_pk_bf16_f32 v141, v46, v47
    v_exp_f32 v49, v49
    v_mfma_f32_32x32x16_bf16 v[28:43], v[164:167], v[128:131], v[28:43]
    v_exp_f32 v50, v50
    v_cvt_pk_bf16_f32 v142, v48, v49
    v_exp_f32 v51, v51
    v_exp_f32 v52, v52
    v_cvt_pk_bf16_f32 v143, v50, v51
    v_exp_f32 v53, v53
    v_exp_f32 v54, v54
    v_mfma_f32_32x32x16_bf16 v[108:123], v[168:171], v[140:143], v[108:123]
    ds_read_b128 v[168:171], v20 offset:10240
    v_exp_f32 v55, v55
    v_cvt_pk_bf16_f32 v144, v52, v53
    v_exp_f32 v56, v56
    v_cvt_pk_bf16_f32 v145, v54, v55
    v_exp_f32 v57, v57
    v_exp_f32 v58, v58
    v_exp_f32 v59, v59
    v_cvt_pk_bf16_f32 v146, v56, v57
    v_cvt_pk_bf16_f32 v147, v58, v59
    v_mfma_f32_32x32x16_bf16 v[44:59], v[160:163], v[132:135], v[76:91]
    ds_read_b128 v[160:163], v20 offset:12288
    v_exp_f32 v28, v28
    v_exp_f32 v29, v29
    v_exp_f32 v30, v30
    v_smfmac_f32_16x16x64_bf16 v[152:155], v[156:159], v[140:147], v22
    v_exp_f32 v31, v31
    v_mfma_f32_32x32x16_bf16 v[108:123], v[172:175], v[144:147], v[108:123]
    ds_read_b128 v[172:175], v20 offset:11264
    v_cvt_pk_bf16_f32 v140, v28, v29
    v_exp_f32 v32, v32
    v_cvt_pk_bf16_f32 v141, v30, v31
    v_exp_f32 v33, v33
    v_mfma_f32_32x32x16_bf16 v[44:59], v[164:167], v[136:139], v[44:59]
    ds_read_b128 v[164:167], v20 offset:13312
    v_exp_f32 v34, v34
    v_cvt_pk_bf16_f32 v142, v32, v33
    v_exp_f32 v35, v35
    v_exp_f32 v36, v36
    v_cvt_pk_bf16_f32 v143, v34, v35
    v_exp_f32 v37, v37
    v_exp_f32 v38, v38
    s_waitcnt lgkmcnt(3)
    v_mfma_f32_32x32x16_bf16 v[92:107], v[168:171], v[140:143], v[92:107]
    v_exp_f32 v39, v39
    v_cvt_pk_bf16_f32 v144, v36, v37
    v_exp_f32 v40, v40
    v_cvt_pk_bf16_f32 v145, v38, v39
    v_exp_f32 v41, v41
    v_exp_f32 v42, v42
    v_exp_f32 v43, v43
    v_cvt_pk_bf16_f32 v146, v40, v41
    v_cvt_pk_bf16_f32 v147, v42, v43
    s_waitcnt lgkmcnt(0)
    v_mfma_f32_32x32x16_bf16 v[28:43], v[160:163], v[124:127], v[60:75]
    v_exp_f32 v44, v44
    v_exp_f32 v45, v45
    v_exp_f32 v46, v46
    v_smfmac_f32_16x16x64_bf16 v[148:151], v[156:159], v[140:147], v22
    v_exp_f32 v47, v47
    v_mfma_f32_32x32x16_bf16 v[92:107], v[172:175], v[144:147], v[92:107]
    v_cvt_pk_bf16_f32 v140, v44, v45
    v_exp_f32 v48, v48
    v_cvt_pk_bf16_f32 v141, v46, v47
    v_exp_f32 v49, v49
    v_mfma_f32_32x32x16_bf16 v[28:43], v[164:167], v[128:131], v[28:43]
    v_exp_f32 v50, v50
    v_cvt_pk_bf16_f32 v142, v48, v49
    v_exp_f32 v51, v51
    v_exp_f32 v52, v52
    v_cvt_pk_bf16_f32 v143, v50, v51
    v_exp_f32 v53, v53
    v_exp_f32 v54, v54
    v_mfma_f32_32x32x16_bf16 v[108:123], v[168:171], v[140:143], v[108:123]
    ds_read_b128 v[168:171], v20 offset:14336
    v_exp_f32 v55, v55
    v_cvt_pk_bf16_f32 v144, v52, v53
    v_exp_f32 v56, v56
    v_cvt_pk_bf16_f32 v145, v54, v55
    v_exp_f32 v57, v57
    v_exp_f32 v58, v58
    v_exp_f32 v59, v59
    v_cvt_pk_bf16_f32 v146, v56, v57
    v_cvt_pk_bf16_f32 v147, v58, v59
    v_mfma_f32_32x32x16_bf16 v[44:59], v[160:163], v[132:135], v[76:91]
    ds_read_b128 v[160:163], v20 offset:16384
    v_exp_f32 v28, v28
    v_exp_f32 v29, v29
    v_exp_f32 v30, v30
    v_smfmac_f32_16x16x64_bf16 v[152:155], v[156:159], v[140:147], v22
    v_exp_f32 v31, v31
    v_mfma_f32_32x32x16_bf16 v[108:123], v[172:175], v[144:147], v[108:123]
    ds_read_b128 v[172:175], v20 offset:15360
    v_cvt_pk_bf16_f32 v140, v28, v29
    v_exp_f32 v32, v32
    v_cvt_pk_bf16_f32 v141, v30, v31
    v_exp_f32 v33, v33
    v_mfma_f32_32x32x16_bf16 v[44:59], v[164:167], v[136:139], v[44:59]
    ds_read_b128 v[164:167], v20 offset:17408
    v_exp_f32 v34, v34
    v_cvt_pk_bf16_f32 v142, v32, v33
    v_exp_f32 v35, v35
    v_exp_f32 v36, v36
    v_cvt_pk_bf16_f32 v143, v34, v35
    v_exp_f32 v37, v37
    v_exp_f32 v38, v38
    s_waitcnt lgkmcnt(3)
    v_mfma_f32_32x32x16_bf16 v[92:107], v[168:171], v[140:143], v[92:107]
    v_exp_f32 v39, v39
    v_cvt_pk_bf16_f32 v144, v36, v37
    v_exp_f32 v40, v40
    v_cvt_pk_bf16_f32 v145, v38, v39
    v_exp_f32 v41, v41
    v_exp_f32 v42, v42
    v_exp_f32 v43, v43
    v_cvt_pk_bf16_f32 v146, v40, v41
    v_cvt_pk_bf16_f32 v147, v42, v43
    s_waitcnt lgkmcnt(0)
    v_mfma_f32_32x32x16_bf16 v[28:43], v[160:163], v[124:127], v[60:75]
    v_exp_f32 v44, v44
    v_exp_f32 v45, v45
    v_exp_f32 v46, v46
    v_smfmac_f32_16x16x64_bf16 v[148:151], v[156:159], v[140:147], v22
    v_exp_f32 v47, v47
    v_mfma_f32_32x32x16_bf16 v[92:107], v[172:175], v[144:147], v[92:107]
    v_cvt_pk_bf16_f32 v140, v44, v45
    v_exp_f32 v48, v48
    v_cvt_pk_bf16_f32 v141, v46, v47
    v_exp_f32 v49, v49
    v_mfma_f32_32x32x16_bf16 v[28:43], v[164:167], v[128:131], v[28:43]
    v_exp_f32 v50, v50
    v_cvt_pk_bf16_f32 v142, v48, v49
    v_exp_f32 v51, v51
    v_exp_f32 v52, v52
    v_cvt_pk_bf16_f32 v143, v50, v51
    v_exp_f32 v53, v53
    v_exp_f32 v54, v54
    v_mfma_f32_32x32x16_bf16 v[108:123], v[168:171], v[140:143], v[108:123]
    ds_read_b128 v[168:171], v20 offset:18432
    v_exp_f32 v55, v55
    v_cvt_pk_bf16_f32 v144, v52, v53
    v_exp_f32 v56, v56
    v_cvt_pk_bf16_f32 v145, v54, v55
    v_exp_f32 v57, v57
    v_exp_f32 v58, v58
    v_exp_f32 v59, v59
    v_cvt_pk_bf16_f32 v146, v56, v57
    v_cvt_pk_bf16_f32 v147, v58, v59
    s_barrier
    v_mfma_f32_32x32x16_bf16 v[44:59], v[160:163], v[132:135], v[76:91]
    ds_read_b128 v[160:163], v20 offset:20480
    v_exp_f32 v28, v28
    v_exp_f32 v29, v29
    v_exp_f32 v30, v30
    v_smfmac_f32_16x16x64_bf16 v[152:155], v[156:159], v[140:147], v22
    v_exp_f32 v31, v31
    v_mfma_f32_32x32x16_bf16 v[108:123], v[172:175], v[144:147], v[108:123]
    ds_read_b128 v[172:175], v20 offset:19456
    v_cvt_pk_bf16_f32 v140, v28, v29
    v_exp_f32 v32, v32
    v_cvt_pk_bf16_f32 v141, v30, v31
    v_exp_f32 v33, v33
    v_mfma_f32_32x32x16_bf16 v[44:59], v[164:167], v[136:139], v[44:59]
    ds_read_b128 v[164:167], v20 offset:21504
    v_exp_f32 v34, v34
    v_cvt_pk_bf16_f32 v142, v32, v33
    v_exp_f32 v35, v35
    v_exp_f32 v36, v36
    v_cvt_pk_bf16_f32 v143, v34, v35
    v_exp_f32 v37, v37
    v_exp_f32 v38, v38
    s_waitcnt lgkmcnt(3)
    v_mfma_f32_32x32x16_bf16 v[92:107], v[168:171], v[140:143], v[92:107]
    v_exp_f32 v39, v39
    v_cvt_pk_bf16_f32 v144, v36, v37
    v_exp_f32 v40, v40
    v_cvt_pk_bf16_f32 v145, v38, v39
    v_exp_f32 v41, v41
    v_exp_f32 v42, v42
    v_exp_f32 v43, v43
    v_cvt_pk_bf16_f32 v146, v40, v41
    v_cvt_pk_bf16_f32 v147, v42, v43
    s_waitcnt lgkmcnt(0)
    v_mfma_f32_32x32x16_bf16 v[28:43], v[160:163], v[124:127], v[60:75]
    v_exp_f32 v44, v44
    v_exp_f32 v45, v45
    v_exp_f32 v46, v46
    v_smfmac_f32_16x16x64_bf16 v[148:151], v[156:159], v[140:147], v22
    v_exp_f32 v47, v47
    v_mfma_f32_32x32x16_bf16 v[92:107], v[172:175], v[144:147], v[92:107]
    v_cvt_pk_bf16_f32 v140, v44, v45
    v_exp_f32 v48, v48
    v_cvt_pk_bf16_f32 v141, v46, v47
    v_exp_f32 v49, v49
    v_mfma_f32_32x32x16_bf16 v[28:43], v[164:167], v[128:131], v[28:43]
    v_exp_f32 v50, v50
    v_cvt_pk_bf16_f32 v142, v48, v49
    v_exp_f32 v51, v51
    v_exp_f32 v52, v52
    v_cvt_pk_bf16_f32 v143, v50, v51
    v_exp_f32 v53, v53
    v_exp_f32 v54, v54
    v_mfma_f32_32x32x16_bf16 v[108:123], v[168:171], v[140:143], v[108:123]
    ds_read_b128 v[168:171], v20 offset:22528
    v_exp_f32 v55, v55
    v_cvt_pk_bf16_f32 v144, v52, v53
    v_exp_f32 v56, v56
    v_cvt_pk_bf16_f32 v145, v54, v55
    v_exp_f32 v57, v57
    v_exp_f32 v58, v58
    v_exp_f32 v59, v59
    v_cvt_pk_bf16_f32 v146, v56, v57
    v_cvt_pk_bf16_f32 v147, v58, v59
    v_mfma_f32_32x32x16_bf16 v[44:59], v[160:163], v[132:135], v[76:91]
    ds_read_b128 v[160:163], v20 offset:24576
    v_exp_f32 v28, v28
    v_exp_f32 v29, v29
    v_exp_f32 v30, v30
    v_smfmac_f32_16x16x64_bf16 v[152:155], v[156:159], v[140:147], v22
    v_exp_f32 v31, v31
    v_mfma_f32_32x32x16_bf16 v[108:123], v[172:175], v[144:147], v[108:123]
    ds_read_b128 v[172:175], v20 offset:23552
    v_cvt_pk_bf16_f32 v140, v28, v29
    v_exp_f32 v32, v32
    v_cvt_pk_bf16_f32 v141, v30, v31
    v_exp_f32 v33, v33
    v_mfma_f32_32x32x16_bf16 v[44:59], v[164:167], v[136:139], v[44:59]
    ds_read_b128 v[164:167], v20 offset:25600
    v_exp_f32 v34, v34
    v_cvt_pk_bf16_f32 v142, v32, v33
    v_exp_f32 v35, v35
    v_exp_f32 v36, v36
    v_cvt_pk_bf16_f32 v143, v34, v35
    v_exp_f32 v37, v37
    v_exp_f32 v38, v38
    s_waitcnt lgkmcnt(3)
    v_mfma_f32_32x32x16_bf16 v[92:107], v[168:171], v[140:143], v[92:107]
    v_exp_f32 v39, v39
    v_cvt_pk_bf16_f32 v144, v36, v37
    v_exp_f32 v40, v40
    v_cvt_pk_bf16_f32 v145, v38, v39
    v_exp_f32 v41, v41
    v_exp_f32 v42, v42
    v_exp_f32 v43, v43
    v_cvt_pk_bf16_f32 v146, v40, v41
    v_cvt_pk_bf16_f32 v147, v42, v43
    s_waitcnt lgkmcnt(0)
    v_mfma_f32_32x32x16_bf16 v[28:43], v[160:163], v[124:127], v[60:75]
    v_exp_f32 v44, v44
    v_exp_f32 v45, v45
    v_exp_f32 v46, v46
    v_smfmac_f32_16x16x64_bf16 v[148:151], v[156:159], v[140:147], v22
    v_exp_f32 v47, v47
    v_mfma_f32_32x32x16_bf16 v[92:107], v[172:175], v[144:147], v[92:107]
    v_cvt_pk_bf16_f32 v140, v44, v45
    v_exp_f32 v48, v48
    v_cvt_pk_bf16_f32 v141, v46, v47
    v_exp_f32 v49, v49
    v_mfma_f32_32x32x16_bf16 v[28:43], v[164:167], v[128:131], v[28:43]
    v_exp_f32 v50, v50
    v_cvt_pk_bf16_f32 v142, v48, v49
    v_exp_f32 v51, v51
    v_exp_f32 v52, v52
    v_cvt_pk_bf16_f32 v143, v50, v51
    v_exp_f32 v53, v53
    v_exp_f32 v54, v54
    v_mfma_f32_32x32x16_bf16 v[108:123], v[168:171], v[140:143], v[108:123]
    ds_read_b128 v[168:171], v20 offset:26624
    v_exp_f32 v55, v55
    v_cvt_pk_bf16_f32 v144, v52, v53
    v_exp_f32 v56, v56
    v_cvt_pk_bf16_f32 v145, v54, v55
    v_exp_f32 v57, v57
    v_exp_f32 v58, v58
    v_exp_f32 v59, v59
    v_cvt_pk_bf16_f32 v146, v56, v57
    v_cvt_pk_bf16_f32 v147, v58, v59
    v_mfma_f32_32x32x16_bf16 v[44:59], v[160:163], v[132:135], v[76:91]
    ds_read_b128 v[160:163], v20 offset:28672
    v_exp_f32 v28, v28
    v_exp_f32 v29, v29
    v_exp_f32 v30, v30
    v_smfmac_f32_16x16x64_bf16 v[152:155], v[156:159], v[140:147], v22
    v_exp_f32 v31, v31
    v_mfma_f32_32x32x16_bf16 v[108:123], v[172:175], v[144:147], v[108:123]
    ds_read_b128 v[172:175], v20 offset:27648
    v_cvt_pk_bf16_f32 v140, v28, v29
    v_exp_f32 v32, v32
    v_cvt_pk_bf16_f32 v141, v30, v31
    v_exp_f32 v33, v33
    v_mfma_f32_32x32x16_bf16 v[44:59], v[164:167], v[136:139], v[44:59]
    ds_read_b128 v[164:167], v20 offset:29696
    v_exp_f32 v34, v34
    v_cvt_pk_bf16_f32 v142, v32, v33
    v_exp_f32 v35, v35
    v_exp_f32 v36, v36
    v_cvt_pk_bf16_f32 v143, v34, v35
    v_exp_f32 v37, v37
    v_exp_f32 v38, v38
    s_waitcnt lgkmcnt(3)
    v_mfma_f32_32x32x16_bf16 v[92:107], v[168:171], v[140:143], v[92:107]
    v_exp_f32 v39, v39
    v_cvt_pk_bf16_f32 v144, v36, v37
    v_exp_f32 v40, v40
    v_cvt_pk_bf16_f32 v145, v38, v39
    v_exp_f32 v41, v41
    v_exp_f32 v42, v42
    v_exp_f32 v43, v43
    v_cvt_pk_bf16_f32 v146, v40, v41
    v_cvt_pk_bf16_f32 v147, v42, v43
    s_waitcnt lgkmcnt(0)
    v_mfma_f32_32x32x16_bf16 v[28:43], v[160:163], v[124:127], v[60:75]
    v_exp_f32 v44, v44
    v_exp_f32 v45, v45
    v_exp_f32 v46, v46
    v_smfmac_f32_16x16x64_bf16 v[148:151], v[156:159], v[140:147], v22
    v_exp_f32 v47, v47
    v_mfma_f32_32x32x16_bf16 v[92:107], v[172:175], v[144:147], v[92:107]
    v_cvt_pk_bf16_f32 v140, v44, v45
    v_exp_f32 v48, v48
    v_cvt_pk_bf16_f32 v141, v46, v47
    v_exp_f32 v49, v49
    v_mfma_f32_32x32x16_bf16 v[28:43], v[164:167], v[128:131], v[28:43]
    v_exp_f32 v50, v50
    v_cvt_pk_bf16_f32 v142, v48, v49
    v_exp_f32 v51, v51
    v_exp_f32 v52, v52
    v_cvt_pk_bf16_f32 v143, v50, v51
    v_exp_f32 v53, v53
    v_exp_f32 v54, v54
    v_mfma_f32_32x32x16_bf16 v[108:123], v[168:171], v[140:143], v[108:123]
    ds_read_b128 v[168:171], v20 offset:30720
    v_exp_f32 v55, v55
    v_cvt_pk_bf16_f32 v144, v52, v53
    v_exp_f32 v56, v56
    v_cvt_pk_bf16_f32 v145, v54, v55
    v_exp_f32 v57, v57
    v_exp_f32 v58, v58
    v_exp_f32 v59, v59
    v_cvt_pk_bf16_f32 v146, v56, v57
    v_cvt_pk_bf16_f32 v147, v58, v59
    v_mfma_f32_32x32x16_bf16 v[44:59], v[160:163], v[132:135], v[76:91]
    ds_read_b128 v[160:163], v21 offset:0
    v_exp_f32 v28, v28
    v_exp_f32 v29, v29
    v_exp_f32 v30, v30
    v_smfmac_f32_16x16x64_bf16 v[152:155], v[156:159], v[140:147], v22
    v_exp_f32 v31, v31
    v_mfma_f32_32x32x16_bf16 v[108:123], v[172:175], v[144:147], v[108:123]
    ds_read_b128 v[172:175], v20 offset:31744
    v_cvt_pk_bf16_f32 v140, v28, v29
    v_exp_f32 v32, v32
    v_cvt_pk_bf16_f32 v141, v30, v31
    v_exp_f32 v33, v33
    v_mfma_f32_32x32x16_bf16 v[44:59], v[164:167], v[136:139], v[44:59]
    ds_read_b128 v[164:167], v21 offset:1024
    v_exp_f32 v34, v34
    v_cvt_pk_bf16_f32 v142, v32, v33
    v_exp_f32 v35, v35
    v_exp_f32 v36, v36
    v_cvt_pk_bf16_f32 v143, v34, v35
    v_exp_f32 v37, v37
    v_exp_f32 v38, v38
    s_waitcnt lgkmcnt(3)
    v_mfma_f32_32x32x16_bf16 v[92:107], v[168:171], v[140:143], v[92:107]
    v_exp_f32 v39, v39
    v_cvt_pk_bf16_f32 v144, v36, v37
    v_exp_f32 v40, v40
    v_cvt_pk_bf16_f32 v145, v38, v39
    v_exp_f32 v41, v41
    v_exp_f32 v42, v42
    v_exp_f32 v43, v43
    v_cvt_pk_bf16_f32 v146, v40, v41
    v_cvt_pk_bf16_f32 v147, v42, v43
    s_mov_b32 s60, s59
    s_add_u32 s59, s59, 32768
    s_cmp_eq_u32 s59, 163840
    s_cselect_b32 s59, 65536, s59
    s_add_u32 s58, s58, 1
    s_cmp_lt_u32 s58, 8
    s_waitcnt lgkmcnt(0)
    v_mfma_f32_32x32x16_bf16 v[28:43], v[160:163], v[124:127], v[60:75]
    v_exp_f32 v44, v44
    v_exp_f32 v45, v45
    v_exp_f32 v46, v46
    v_smfmac_f32_16x16x64_bf16 v[148:151], v[156:159], v[140:147], v22
    v_exp_f32 v47, v47
    v_mfma_f32_32x32x16_bf16 v[92:107], v[172:175], v[144:147], v[92:107]
    v_cvt_pk_bf16_f32 v140, v44, v45
    v_exp_f32 v48, v48
    v_cvt_pk_bf16_f32 v141, v46, v47
    v_exp_f32 v49, v49
    v_mfma_f32_32x32x16_bf16 v[28:43], v[164:167], v[128:131], v[28:43]
    v_exp_f32 v50, v50
    v_cvt_pk_bf16_f32 v142, v48, v49
    v_exp_f32 v51, v51
    v_exp_f32 v52, v52
    v_cvt_pk_bf16_f32 v143, v50, v51
    v_exp_f32 v53, v53
    v_exp_f32 v54, v54
    v_mfma_f32_32x32x16_bf16 v[108:123], v[168:171], v[140:143], v[108:123]
    ds_read_b128 v[168:171], v21 offset:2048
    v_exp_f32 v55, v55
    v_cvt_pk_bf16_f32 v144, v52, v53
    v_exp_f32 v56, v56
    v_cvt_pk_bf16_f32 v145, v54, v55
    v_exp_f32 v57, v57
    v_exp_f32 v58, v58
    v_exp_f32 v59, v59
    v_cvt_pk_bf16_f32 v146, v56, v57
    v_cvt_pk_bf16_f32 v147, v58, v59
    v_mov_b32 v20, v21
    v_add_u32 v21, s60, v2
    s_cbranch_scc1 L_bloop_21
    v_smfmac_f32_16x16x64_bf16 v[152:155], v[156:159], v[140:147], v22
    v_mfma_f32_32x32x16_bf16 v[108:123], v[172:175], v[144:147], v[108:123]
    s_waitcnt lgkmcnt(0)
    s_setprio 0
    v_add_f32 v148, v148, v149
    v_rcp_f32 v150, v148
    s_nop 0
    v_pk_mul_f32 v[92:93], v[92:93], v[150:151] op_sel_hi:[1,0]
    v_pk_mul_f32 v[94:95], v[94:95], v[150:151] op_sel_hi:[1,0]
    v_pk_mul_f32 v[96:97], v[96:97], v[150:151] op_sel_hi:[1,0]
    v_pk_mul_f32 v[98:99], v[98:99], v[150:151] op_sel_hi:[1,0]
    v_pk_mul_f32 v[100:101], v[100:101], v[150:151] op_sel_hi:[1,0]
    v_pk_mul_f32 v[102:103], v[102:103], v[150:151] op_sel_hi:[1,0]
    v_pk_mul_f32 v[104:105], v[104:105], v[150:151] op_sel_hi:[1,0]
    v_pk_mul_f32 v[106:107], v[106:107], v[150:151] op_sel_hi:[1,0]
    v_cvt_pk_bf16_f32 v176, v92, v93
    v_cvt_pk_bf16_f32 v177, v94, v95
    v_cvt_pk_bf16_f32 v178, v100, v101
    v_cvt_pk_bf16_f32 v179, v102, v103
    buffer_store_dwordx4 v[176:179], v11, s[32:35], s62 offen offset:0 sc1
    v_cvt_pk_bf16_f32 v180, v96, v97
    v_cvt_pk_bf16_f32 v181, v98, v99
    v_cvt_pk_bf16_f32 v182, v104, v105
    v_cvt_pk_bf16_f32 v183, v106, v107
    buffer_store_dwordx4 v[180:183], v11, s[32:35], s62 offen offset:512 sc1
    v_add_f32 v152, v152, v153
    v_rcp_f32 v154, v152
    s_nop 0
    v_pk_mul_f32 v[108:109], v[108:109], v[154:155] op_sel_hi:[1,0]
    v_pk_mul_f32 v[110:111], v[110:111], v[154:155] op_sel_hi:[1,0]
    v_pk_mul_f32 v[112:113], v[112:113], v[154:155] op_sel_hi:[1,0]
    v_pk_mul_f32 v[114:115], v[114:115], v[154:155] op_sel_hi:[1,0]
    v_pk_mul_f32 v[116:117], v[116:117], v[154:155] op_sel_hi:[1,0]
    v_pk_mul_f32 v[118:119], v[118:119], v[154:155] op_sel_hi:[1,0]
    v_pk_mul_f32 v[120:121], v[120:121], v[154:155] op_sel_hi:[1,0]
    v_pk_mul_f32 v[122:123], v[122:123], v[154:155] op_sel_hi:[1,0]
    v_cvt_pk_bf16_f32 v184, v108, v109
    v_cvt_pk_bf16_f32 v185, v110, v111
    v_cvt_pk_bf16_f32 v186, v116, v117
    v_cvt_pk_bf16_f32 v187, v118, v119
    buffer_store_dwordx4 v[184:187], v11, s[32:35], s63 offen offset:0 sc1
    v_cvt_pk_bf16_f32 v188, v112, v113
    v_cvt_pk_bf16_f32 v189, v114, v115
    v_cvt_pk_bf16_f32 v190, v120, v121
    v_cvt_pk_bf16_f32 v191, v122, v123
    buffer_store_dwordx4 v[188:191], v11, s[32:35], s63 offen offset:512 sc1
    s_cmp_eq_u32 s36, 0
    s_cbranch_scc1 L_chk_20
    s_barrier
    s_branch L_chain_entry
L_chk_20:
    v_mov_b32 v4, 0x71800000
    v_add_f32 v3, v148, v152
    v_cmp_nlt_f32 vcc, v3, v4
    s_lshl_b32 s3, s24, 2
    v_mov_b32 v3, s3
    s_cmp_lg_u64 vcc, 0
    s_cselect_b32 s3, 1, 0
    v_mov_b32 v4, s3
    ds_write_b32 v3, v4 offset:28672
    s_waitcnt lgkmcnt(0)
    s_barrier
    v_mov_b32 v3, 0
    ds_read_b128 v[160:163], v3 offset:28672
    s_waitcnt lgkmcnt(0)
    v_or3_b32 v160, v160, v161, v162
    v_or_b32 v160, v160, v163
    s_nop 1
    v_readfirstlane_b32 s3, v160
    s_nop 3
    s_cmp_eq_u32 s3, 0
    s_cbranch_scc1 L_chain_entry
    s_mov_b32 s36, 1
    s_mov_b32 s61, 4194304
    v_mov_b32 v23, 0xff800000
    v_mov_b32 v24, 0xff800000
L_maxloop_22:
    buffer_load_dwordx4 v[160:163], v2, s[32:35], s61 offen sc1
    buffer_load_dwordx4 v[164:167], v2, s[32:35], s61 offen offset:1024 sc1
    s_waitcnt vmcnt(0)
    v_mfma_f32_32x32x16_bf16 v[28:43], v[160:163], v[124:127], 0
    v_mfma_f32_32x32x16_bf16 v[28:43], v[164:167], v[128:131], v[28:43]
    v_mfma_f32_32x32x16_bf16 v[44:59], v[160:163], v[132:135], 0
    v_mfma_f32_32x32x16_bf16 v[44:59], v[164:167], v[136:139], v[44:59]
    s_nop 15
    s_nop 3
    v_max3_f32 v23, v23, v28, v29
    v_max3_f32 v23, v23, v30, v31
    v_max3_f32 v23, v23, v32, v33
    v_max3_f32 v23, v23, v34, v35
    v_max3_f32 v23, v23, v36, v37
    v_max3_f32 v23, v23, v38, v39
    v_max3_f32 v23, v23, v40, v41
    v_max3_f32 v23, v23, v42, v43
    v_max3_f32 v24, v24, v44, v45
    v_max3_f32 v24, v24, v46, v47
    v_max3_f32 v24, v24, v48, v49
    v_max3_f32 v24, v24, v50, v51
    v_max3_f32 v24, v24, v52, v53
    v_max3_f32 v24, v24, v54, v55
    v_max3_f32 v24, v24, v56, v57
    v_max3_f32 v24, v24, v58, v59
    s_add_u32 s61, s61, 4096
    s_cmp_lt_u32 s61, 4456448
    s_cbranch_scc1 L_maxloop_22
    s_barrier
    v_add_u32 v20, 98304, v2
    ds_read_b128 v[160:163], v20
    ds_read_b128 v[164:167], v20 offset:1024
    s_waitcnt lgkmcnt(0)
    s_branch L_bstart_19
L_chain_entry:
    s_load_dwordx2 s[4:5], s[0:1], 0
    s_load_dwordx2 s[6:7], s[0:1], 32
    s_load_dwordx2 s[8:9], s[0:1], 96
    s_load_dwordx2 s[10:11], s[0:1], 64
    s_load_dwordx2 s[12:13], s[0:1], 80
    v_lshrrev_b32 v1, 6, v0
    s_nop 0
    v_readfirstlane_b32 s14, v1
    v_and_b32 v1, 63, v0
    v_lshlrev_b32 v2, 4, v1
    s_and_b32 s16, s14, 3
    s_mov_b32 s22, 83886080
    s_mov_b32 s23, 0x20000
    s_and_b32 s26, s2, 7
    s_lshr_b32 s24, s26, 1
    s_lshl_b32 s24, s24, 2
    s_and_b32 s25, s26, 1
    s_lshl_b32 s25, s25, 3
    s_lshr_b32 s27, s2, 6
    s_add_u32 s24, s24, s27
    s_lshr_b32 s26, s2, 3
    s_and_b32 s26, s26, 7
    s_add_u32 s25, s25, s26
    s_cmp_lt_u32 s14, 4
    s_cbranch_scc1 L_comp_23
    s_lshl_b32 s36, s24, 18
    s_lshl_b32 s37, s25, 7
    s_add_u32 s38, s36, s37
    s_add_u32 s36, s36, 5242880
    s_mov_b32 s30, 2097152
    s_mov_b32 s31, 0x20000
    s_mov_b32 s39, 0
    s_mul_i32 s40, s16, 4096
    v_add_u32 v6, s40, v2
    s_mov_b32 s39, 131072
    s_mov_b32 s41, 49152
    s_mul_i32 s42, s16, 2048
    v_add_u32 v7, s42, v2
    s_lshl_b32 s3, s16, 4
    v_lshrrev_b32 v4, 3, v1
    v_add_u32 v4, s3, v4
    v_and_b32 v3, 7, v1
    v_bfe_u32 v5, v1, 4, 2
    v_lshlrev_b32 v5, 1, v5
    v_xor_b32 v3, v3, v5
    v_mul_u32_u24 v4, 2048, v4
    v_lshl_add_u32 v7, v3, 4, v4
    v_add_u32 v8, 15360, v7
    s_waitcnt lgkmcnt(0)
    s_add_u32 s20, s8, 0
    s_addc_u32 s21, s9, 0
    s_mov_b64 s[28:29], s[6:7]
    s_waitcnt vmcnt(0)
    s_add_u32 s37, s37, 1310720
    s_barrier
    s_barrier
    s_add_u32 m0, s39, s40
    s_nop 0
    buffer_load_dwordx4 v6, s[20:23], s36 offen offset:0 sc1 lds
    buffer_load_dwordx4 v6, s[20:23], s36 offen offset:1024 sc1 lds
    buffer_load_dwordx4 v6, s[20:23], s36 offen offset:2048 sc1 lds
    buffer_load_dwordx4 v6, s[20:23], s36 offen offset:3072 sc1 lds
    s_add_u32 s36, s36, 16384
    s_add_u32 s39, s39, 16384
    s_cmp_eq_u32 s39, 32768
    s_cselect_b32 s39, 131072, s39
    s_cmp_eq_u32 s39, 163840
    s_cselect_b32 s39, 0, s39
    s_add_u32 m0, s39, s40
    s_nop 0
    buffer_load_dwordx4 v6, s[20:23], s36 offen offset:0 sc1 lds
    buffer_load_dwordx4 v6, s[20:23], s36 offen offset:1024 sc1 lds
    buffer_load_dwordx4 v6, s[20:23], s36 offen offset:2048 sc1 lds
    buffer_load_dwordx4 v6, s[20:23], s36 offen offset:3072 sc1 lds
    s_add_u32 s36, s36, 16384
    s_add_u32 s39, s39, 16384
    s_cmp_eq_u32 s39, 32768
    s_cselect_b32 s39, 131072, s39
    s_cmp_eq_u32 s39, 163840
    s_cselect_b32 s39, 0, s39
    s_add_u32 m0, s39, s40
    s_nop 0
    buffer_load_dwordx4 v6, s[20:23], s36 offen offset:0 sc1 lds
    buffer_load_dwordx4 v6, s[20:23], s36 offen offset:1024 sc1 lds
    buffer_load_dwordx4 v6, s[20:23], s36 offen offset:2048 sc1 lds
    buffer_load_dwordx4 v6, s[20:23], s36 offen offset:3072 sc1 lds
    s_add_u32 s36, s36, 16384
    s_add_u32 s39, s39, 16384
    s_cmp_eq_u32 s39, 32768
    s_cselect_b32 s39, 131072, s39
    s_cmp_eq_u32 s39, 163840
    s_cselect_b32 s39, 0, s39
    s_waitcnt vmcnt(8)
    s_barrier
    s_add_u32 m0, s39, s40
    s_nop 0
    buffer_load_dwordx4 v6, s[20:23], s36 offen offset:0 sc1 lds
    buffer_load_dwordx4 v6, s[20:23], s36 offen offset:1024 sc1 lds
    buffer_load_dwordx4 v6, s[20:23], s36 offen offset:2048 sc1 lds
    buffer_load_dwordx4 v6, s[20:23], s36 offen offset:3072 sc1 lds
    s_add_u32 s36, s36, 16384
    s_add_u32 s39, s39, 16384
    s_cmp_eq_u32 s39, 32768
    s_cselect_b32 s39, 131072, s39
    s_cmp_eq_u32 s39, 163840
    s_cselect_b32 s39, 0, s39
    s_waitcnt vmcnt(8)
    s_barrier
    s_add_u32 m0, s39, s40
    s_nop 0
    buffer_load_dwordx4 v6, s[20:23], s36 offen offset:0 sc1 lds
    buffer_load_dwordx4 v6, s[20:23], s36 offen offset:1024 sc1 lds
    buffer_load_dwordx4 v6, s[20:23], s36 offen offset:2048 sc1 lds
    buffer_load_dwordx4 v6, s[20:23], s36 offen offset:3072 sc1 lds
    s_add_u32 s36, s36, 16384
    s_add_u32 s39, s39, 16384
    s_cmp_eq_u32 s39, 32768
    s_cselect_b32 s39, 131072, s39
    s_cmp_eq_u32 s39, 163840
    s_cselect_b32 s39, 0, s39
    s_add_u32 m0, s41, s42
    s_nop 0
    buffer_load_dwordx4 v7, s[28:31], s37 offen lds
    buffer_load_dwordx4 v8, s[28:31], s37 offen offset:1024 lds
    s_add_u32 s37, s37, 131072
    s_add_u32 s41, s41, 8192
    s_cmp_eq_u32 s41, 131072
    s_cselect_b32 s41, 49152, s41
    s_waitcnt vmcnt(10)
    s_barrier
    s_add_u32 m0, s39, s40
    s_nop 0
    buffer_load_dwordx4 v6, s[20:23], s36 offen offset:0 sc1 lds
    buffer_load_dwordx4 v6, s[20:23], s36 offen offset:1024 sc1 lds
    buffer_load_dwordx4 v6, s[20:23], s36 offen offset:2048 sc1 lds
    buffer_load_dwordx4 v6, s[20:23], s36 offen offset:3072 sc1 lds
    s_add_u32 s36, s36, 16384
    s_add_u32 s39, s39, 16384
    s_cmp_eq_u32 s39, 32768
    s_cselect_b32 s39, 131072, s39
    s_cmp_eq_u32 s39, 163840
    s_cselect_b32 s39, 0, s39
    s_add_u32 m0, s41, s42
    s_nop 0
    buffer_load_dwordx4 v7, s[28:31], s37 offen lds
    buffer_load_dwordx4 v8, s[28:31], s37 offen offset:1024 lds
    s_add_u32 s37, s37, 131072
    s_add_u32 s41, s41, 8192
    s_cmp_eq_u32 s41, 131072
    s_cselect_b32 s41, 49152, s41
    s_waitcnt vmcnt(12)
    s_barrier
    s_add_u32 m0, s39, s40
    s_nop 0
    buffer_load_dwordx4 v6, s[20:23], s36 offen offset:0 sc1 lds
    buffer_load_dwordx4 v6, s[20:23], s36 offen offset:1024 sc1 lds
    buffer_load_dwordx4 v6, s[20:23], s36 offen offset:2048 sc1 lds
    buffer_load_dwordx4 v6, s[20:23], s36 offen offset:3072 sc1 lds
    s_add_u32 s36, s36, 16384
    s_add_u32 s39, s39, 16384
    s_cmp_eq_u32 s39, 32768
    s_cselect_b32 s39, 131072, s39
    s_cmp_eq_u32 s39, 163840
    s_cselect_b32 s39, 0, s39
    s_add_u32 m0, s41, s42
    s_nop 0
    buffer_load_dwordx4 v7, s[28:31], s37 offen lds
    buffer_load_dwordx4 v8, s[28:31], s37 offen offset:1024 lds
    s_add_u32 s37, s37, 131072
    s_add_u32 s41, s41, 8192
    s_cmp_eq_u32 s41, 131072
    s_cselect_b32 s41, 49152, s41
    s_mov_b32 s15, 3
L_ll_24:
    s_waitcnt vmcnt(14)
    s_barrier
    s_add_u32 m0, s39, s40
    s_nop 0
    buffer_load_dwordx4 v6, s[20:23], s36 offen offset:0 sc1 lds
    buffer_load_dwordx4 v6, s[20:23], s36 offen offset:1024 sc1 lds
    buffer_load_dwordx4 v6, s[20:23], s36 offen offset:2048 sc1 lds
    buffer_load_dwordx4 v6, s[20:23], s36 offen offset:3072 sc1 lds
    s_add_u32 s36, s36, 16384
    s_add_u32 s39, s39, 16384
    s_cmp_eq_u32 s39, 32768
    s_cselect_b32 s39, 131072, s39
    s_cmp_eq_u32 s39, 163840
    s_cselect_b32 s39, 0, s39
    s_add_u32 m0, s41, s42
    s_nop 0
    buffer_load_dwordx4 v7, s[28:31], s37 offen lds
    buffer_load_dwordx4 v8, s[28:31], s37 offen offset:1024 lds
    s_add_u32 s37, s37, 131072
    s_add_u32 s41, s41, 8192
    s_cmp_eq_u32 s41, 131072
    s_cselect_b32 s41, 49152, s41
    s_sub_u32 s15, s15, 1
    s_cmp_lg_u32 s15, 0
    s_nop 7
    s_cbranch_scc1 L_ll_24
    s_waitcnt vmcnt(14)
    s_barrier
    s_add_u32 m0, s39, s40
    s_nop 0
    buffer_load_dwordx4 v6, s[20:23], s36 offen offset:0 sc1 lds
    buffer_load_dwordx4 v6, s[20:23], s36 offen offset:1024 sc1 lds
    buffer_load_dwordx4 v6, s[20:23], s36 offen offset:2048 sc1 lds
    buffer_load_dwordx4 v6, s[20:23], s36 offen offset:3072 sc1 lds
    s_add_u32 s36, s36, 16384
    s_add_u32 s39, s39, 16384
    s_cmp_eq_u32 s39, 32768
    s_cselect_b32 s39, 131072, s39
    s_cmp_eq_u32 s39, 163840
    s_cselect_b32 s39, 0, s39
    s_waitcnt vmcnt(12)
    s_barrier
    s_add_u32 m0, s39, s40
    s_nop 0
    buffer_load_dwordx4 v6, s[20:23], s36 offen offset:0 sc1 lds
    buffer_load_dwordx4 v6, s[20:23], s36 offen offset:1024 sc1 lds
    buffer_load_dwordx4 v6, s[20:23], s36 offen offset:2048 sc1 lds
    buffer_load_dwordx4 v6, s[20:23], s36 offen offset:3072 sc1 lds
    s_add_u32 s36, s36, 16384
    s_add_u32 s39, s39, 16384
    s_cmp_eq_u32 s39, 32768
    s_cselect_b32 s39, 131072, s39
    s_cmp_eq_u32 s39, 163840
    s_cselect_b32 s39, 0, s39
    s_waitcnt vmcnt(10)
    s_barrier
    s_add_u32 m0, s39, s40
    s_nop 0
    buffer_load_dwordx4 v6, s[20:23], s36 offen offset:0 sc1 lds
    buffer_load_dwordx4 v6, s[20:23], s36 offen offset:1024 sc1 lds
    buffer_load_dwordx4 v6, s[20:23], s36 offen offset:2048 sc1 lds
    buffer_load_dwordx4 v6, s[20:23], s36 offen offset:3072 sc1 lds
    s_add_u32 s36, s36, 16384
    s_add_u32 s39, s39, 16384
    s_cmp_eq_u32 s39, 32768
    s_cselect_b32 s39, 131072, s39
    s_cmp_eq_u32 s39, 163840
    s_cselect_b32 s39, 0, s39
    s_mov_b32 s15, 3
L_ll_25:
    s_waitcnt vmcnt(8)
    s_barrier
    s_add_u32 m0, s39, s40
    s_nop 0
    buffer_load_dwordx4 v6, s[20:23], s36 offen offset:0 sc1 lds
    buffer_load_dwordx4 v6, s[20:23], s36 offen offset:1024 sc1 lds
    buffer_load_dwordx4 v6, s[20:23], s36 offen offset:2048 sc1 lds
    buffer_load_dwordx4 v6, s[20:23], s36 offen offset:3072 sc1 lds
    s_add_u32 s36, s36, 16384
    s_add_u32 s39, s39, 16384
    s_cmp_eq_u32 s39, 32768
    s_cselect_b32 s39, 131072, s39
    s_cmp_eq_u32 s39, 163840
    s_cselect_b32 s39, 0, s39
    s_sub_u32 s15, s15, 1
    s_cmp_lg_u32 s15, 0
    s_nop 7
    s_cbranch_scc1 L_ll_25
    v_lshrrev_b32 v3, 2, v1
    v_lshlrev_b32 v3, 9, v3
    v_and_b32 v4, 3, v1
    v_lshl_add_u32 v3, v4, 4, v3
    v_add_u32 v16, 46235648, v3
    buffer_load_dwordx4 v[12:15], v16, s[20:23], 0 offen sc1
    s_and_b32 s45, s2, 7
    s_lshr_b32 s43, s45, 1
    s_lshl_b32 s43, s43, 2
    s_and_b32 s44, s45, 1
    s_lshl_b32 s44, s44, 3
    s_lshr_b32 s46, s2, 6
    s_add_u32 s43, s43, s46
    s_lshr_b32 s45, s2, 3
    s_and_b32 s45, s45, 7
    s_add_u32 s44, s44, s45
    s_lshl_b32 s47, s43, 18
    s_add_u32 s47, s47, 9437184
    s_mul_i32 s48, s44, 458752
    s_add_u32 s48, s48, 37748736
    s_mov_b32 s49, 0
    s_mul_i32 s50, s16, 4096
    v_add_u32 v17, s50, v2
    s_mov_b32 s51, 81920
    s_mul_i32 s52, s16, 3584
    v_add_u32 v18, s52, v2
    s_waitcnt vmcnt(9)
    s_barrier
    s_waitcnt vmcnt(5)
    s_barrier
    s_waitcnt vmcnt(1)
    s_barrier
    s_waitcnt vmcnt(0)
    s_barrier
L_rp_26:
    v_or3_b32 v12, v12, v13, v14
    v_or_b32 v12, v12, v15
    v_cmp_ne_u32 vcc, 0, v12
    s_cbranch_vccz L_rp_26x
    s_sleep 8
    buffer_load_dwordx4 v[12:15], v16, s[20:23], 0 offen sc1
    s_waitcnt vmcnt(0)
    s_branch L_rp_26
L_rp_26x:
    s_mov_b32 s15, 3
L_ll_27:
    s_add_u32 m0, s51, s52
    s_nop 0
    buffer_load_dwordx4 v18, s[20:23], s48 offen offset:0 sc1 lds
    buffer_load_dwordx4 v18, s[20:23], s48 offen offset:1024 sc1 lds
    buffer_load_dwordx4 v18, s[20:23], s48 offen offset:2048 sc1 lds
    s_mov_b32 exec_hi, 0
    buffer_load_dwordx4 v18, s[20:23], s48 offen offset:3072 sc1 lds
    s_mov_b32 exec_hi, -1
    s_add_u32 s48, s48, 14336
    s_add_u32 s51, s51, 14336
    s_cmp_eq_u32 s51, 153600
    s_cselect_b32 s51, 81920, s51
    s_sub_u32 s15, s15, 1
    s_cmp_lg_u32 s15, 0
    s_nop 7
    s_cbranch_scc1 L_ll_27
    s_barrier
    s_barrier
    s_add_u32 m0, s51, s52
    s_nop 0
    buffer_load_dwordx4 v18, s[20:23], s48 offen offset:0 sc1 lds
    buffer_load_dwordx4 v18, s[20:23], s48 offen offset:1024 sc1 lds
    buffer_load_dwordx4 v18, s[20:23], s48 offen offset:2048 sc1 lds
    s_mov_b32 exec_hi, 0
    buffer_load_dwordx4 v18, s[20:23], s48 offen offset:3072 sc1 lds
    s_mov_b32 exec_hi, -1
    s_add_u32 s48, s48, 14336
    s_add_u32 s51, s51, 14336
    s_cmp_eq_u32 s51, 153600
    s_cselect_b32 s51, 81920, s51
    s_add_u32 m0, s51, s52
    s_nop 0
    buffer_load_dwordx4 v18, s[20:23], s48 offen offset:0 sc1 lds
    buffer_load_dwordx4 v18, s[20:23], s48 offen offset:1024 sc1 lds
    buffer_load_dwordx4 v18, s[20:23], s48 offen offset:2048 sc1 lds
    s_mov_b32 exec_hi, 0
    buffer_load_dwordx4 v18, s[20:23], s48 offen offset:3072 sc1 lds
    s_mov_b32 exec_hi, -1
    s_add_u32 s48, s48, 14336
    s_add_u32 s51, s51, 14336
    s_cmp_eq_u32 s51, 153600
    s_cselect_b32 s51, 81920, s51
    s_barrier
    s_add_u32 m0, s49, s50
    s_nop 0
    buffer_load_dwordx4 v17, s[20:23], s47 offen offset:0 sc1 lds
    buffer_load_dwordx4 v17, s[20:23], s47 offen offset:1024 sc1 lds
    buffer_load_dwordx4 v17, s[20:23], s47 offen offset:2048 sc1 lds
    buffer_load_dwordx4 v17, s[20:23], s47 offen offset:3072 sc1 lds
    s_add_u32 s47, s47, 16384
    s_add_u32 s49, s49, 16384
    s_cmp_eq_u32 s49, 81920
    s_cselect_b32 s49, 0, s49
    s_add_u32 m0, s49, s50
    s_nop 0
    buffer_load_dwordx4 v17, s[20:23], s47 offen offset:0 sc1 lds
    buffer_load_dwordx4 v17, s[20:23], s47 offen offset:1024 sc1 lds
    buffer_load_dwordx4 v17, s[20:23], s47 offen offset:2048 sc1 lds
    buffer_load_dwordx4 v17, s[20:23], s47 offen offset:3072 sc1 lds
    s_add_u32 s47, s47, 16384
    s_add_u32 s49, s49, 16384
    s_cmp_eq_u32 s49, 81920
    s_cselect_b32 s49, 0, s49
    s_waitcnt vmcnt(4)
    s_barrier
    s_add_u32 m0, s49, s50
    s_nop 0
    buffer_load_dwordx4 v17, s[20:23], s47 offen offset:0 sc1 lds
    buffer_load_dwordx4 v17, s[20:23], s47 offen offset:1024 sc1 lds
    buffer_load_dwordx4 v17, s[20:23], s47 offen offset:2048 sc1 lds
    buffer_load_dwordx4 v17, s[20:23], s47 offen offset:3072 sc1 lds
    s_add_u32 s47, s47, 16384
    s_add_u32 s49, s49, 16384
    s_cmp_eq_u32 s49, 81920
    s_cselect_b32 s49, 0, s49
    s_add_u32 m0, s49, s50
    s_nop 0
    buffer_load_dwordx4 v17, s[20:23], s47 offen offset:0 sc1 lds
    buffer_load_dwordx4 v17, s[20:23], s47 offen offset:1024 sc1 lds
    buffer_load_dwordx4 v17, s[20:23], s47 offen offset:2048 sc1 lds
    buffer_load_dwordx4 v17, s[20:23], s47 offen offset:3072 sc1 lds
    s_add_u32 s47, s47, 16384
    s_add_u32 s49, s49, 16384
    s_cmp_eq_u32 s49, 81920
    s_cselect_b32 s49, 0, s49
    s_waitcnt vmcnt(8)
    s_barrier
    s_add_u32 m0, s49, s50
    s_nop 0
    buffer_load_dwordx4 v17, s[20:23], s47 offen offset:0 sc1 lds
    buffer_load_dwordx4 v17, s[20:23], s47 offen offset:1024 sc1 lds
    buffer_load_dwordx4 v17, s[20:23], s47 offen offset:2048 sc1 lds
    buffer_load_dwordx4 v17, s[20:23], s47 offen offset:3072 sc1 lds
    s_add_u32 s47, s47, 16384
    s_add_u32 s49, s49, 16384
    s_cmp_eq_u32 s49, 81920
    s_cselect_b32 s49, 0, s49
    s_add_u32 m0, s51, s52
    s_nop 0
    buffer_load_dwordx4 v18, s[20:23], s48 offen offset:0 sc1 lds
    buffer_load_dwordx4 v18, s[20:23], s48 offen offset:1024 sc1 lds
    buffer_load_dwordx4 v18, s[20:23], s48 offen offset:2048 sc1 lds
    s_mov_b32 exec_hi, 0
    buffer_load_dwordx4 v18, s[20:23], s48 offen offset:3072 sc1 lds
    s_mov_b32 exec_hi, -1
    s_add_u32 s48, s48, 14336
    s_add_u32 s51, s51, 14336
    s_cmp_eq_u32 s51, 153600
    s_cselect_b32 s51, 81920, s51
    s_waitcnt vmcnt(12)
    s_barrier
    s_add_u32 m0, s49, s50
    s_nop 0
    buffer_load_dwordx4 v17, s[20:23], s47 offen offset:0 sc1 lds
    buffer_load_dwordx4 v17, s[20:23], s47 offen offset:1024 sc1 lds
    buffer_load_dwordx4 v17, s[20:23], s47 offen offset:2048 sc1 lds
    buffer_load_dwordx4 v17, s[20:23], s47 offen offset:3072 sc1 lds
    s_add_u32 s47, s47, 16384
    s_add_u32 s49, s49, 16384
    s_cmp_eq_u32 s49, 81920
    s_cselect_b32 s49, 0, s49
    s_add_u32 m0, s51, s52
    s_nop 0
    buffer_load_dwordx4 v18, s[20:23], s48 offen offset:0 sc1 lds
    buffer_load_dwordx4 v18, s[20:23], s48 offen offset:1024 sc1 lds
    buffer_load_dwordx4 v18, s[20:23], s48 offen offset:2048 sc1 lds
    s_mov_b32 exec_hi, 0
    buffer_load_dwordx4 v18, s[20:23], s48 offen offset:3072 sc1 lds
    s_mov_b32 exec_hi, -1
    s_add_u32 s48, s48, 14336
    s_add_u32 s51, s51, 14336
    s_cmp_eq_u32 s51, 153600
    s_cselect_b32 s51, 81920, s51
    s_waitcnt vmcnt(16)
    s_barrier
    s_add_u32 m0, s49, s50
    s_nop 0
    buffer_load_dwordx4 v17, s[20:23], s47 offen offset:0 sc1 lds
    buffer_load_dwordx4 v17, s[20:23], s47 offen offset:1024 sc1 lds
    buffer_load_dwordx4 v17, s[20:23], s47 offen offset:2048 sc1 lds
    buffer_load_dwordx4 v17, s[20:23], s47 offen offset:3072 sc1 lds
    s_add_u32 s47, s47, 16384
    s_add_u32 s49, s49, 16384
    s_cmp_eq_u32 s49, 81920
    s_cselect_b32 s49, 0, s49
    s_waitcnt vmcnt(16)
    s_barrier
    s_add_u32 m0, s51, s52
    s_nop 0
    buffer_load_dwordx4 v18, s[20:23], s48 offen offset:0 sc1 lds
    buffer_load_dwordx4 v18, s[20:23], s48 offen offset:1024 sc1 lds
    buffer_load_dwordx4 v18, s[20:23], s48 offen offset:2048 sc1 lds
    s_mov_b32 exec_hi, 0
    buffer_load_dwordx4 v18, s[20:23], s48 offen offset:3072 sc1 lds
    s_mov_b32 exec_hi, -1
    s_add_u32 s48, s48, 14336
    s_add_u32 s51, s51, 14336
    s_cmp_eq_u32 s51, 153600
    s_cselect_b32 s51, 81920, s51
    s_add_u32 m0, s49, s50
    s_nop 0
    buffer_load_dwordx4 v17, s[20:23], s47 offen offset:0 sc1 lds
    buffer_load_dwordx4 v17, s[20:23], s47 offen offset:1024 sc1 lds
    buffer_load_dwordx4 v17, s[20:23], s47 offen offset:2048 sc1 lds
    buffer_load_dwordx4 v17, s[20:23], s47 offen offset:3072 sc1 lds
    s_add_u32 s47, s47, 16384
    s_add_u32 s49, s49, 16384
    s_cmp_eq_u32 s49, 81920
    s_cselect_b32 s49, 0, s49
    s_cmp_ge_u32 s16, 2
    v_and_b32 v53, 127, v0
    v_lshlrev_b32 v52, 3, v53
    s_cbranch_scc1 L_cs_28
    s_lshl_b32 s53, s43, 14
    s_add_u32 s53, s53, 13631488
    buffer_load_dwordx2 v[20:21], v52, s[20:23], s53 offen offset:0 sc1
    buffer_load_dwordx2 v[22:23], v52, s[20:23], s53 offen offset:1024 sc1
    buffer_load_dwordx2 v[24:25], v52, s[20:23], s53 offen offset:2048 sc1
    buffer_load_dwordx2 v[26:27], v52, s[20:23], s53 offen offset:3072 sc1
    s_add_u32 s53, s53, 4096
    buffer_load_dwordx2 v[28:29], v52, s[20:23], s53 offen offset:0 sc1
    buffer_load_dwordx2 v[30:31], v52, s[20:23], s53 offen offset:1024 sc1
    buffer_load_dwordx2 v[32:33], v52, s[20:23], s53 offen offset:2048 sc1
    buffer_load_dwordx2 v[34:35], v52, s[20:23], s53 offen offset:3072 sc1
    s_add_u32 s53, s53, 4096
    buffer_load_dwordx2 v[36:37], v52, s[20:23], s53 offen offset:0 sc1
    buffer_load_dwordx2 v[38:39], v52, s[20:23], s53 offen offset:1024 sc1
    buffer_load_dwordx2 v[40:41], v52, s[20:23], s53 offen offset:2048 sc1
    buffer_load_dwordx2 v[42:43], v52, s[20:23], s53 offen offset:3072 sc1
    s_add_u32 s53, s53, 4096
    buffer_load_dwordx2 v[44:45], v52, s[20:23], s53 offen offset:0 sc1
    buffer_load_dwordx2 v[46:47], v52, s[20:23], s53 offen offset:1024 sc1
    buffer_load_dwordx2 v[48:49], v52, s[20:23], s53 offen offset:2048 sc1
    buffer_load_dwordx2 v[50:51], v52, s[20:23], s53 offen offset:3072 sc1
    s_branch L_tj_29
L_cs_28:
    v_lshlrev_b32 v53, 3, v1
    s_and_b32 s53, s16, 1
    s_mul_i32 s53, s53, 7168
    s_mul_i32 s3, s44, 448
    s_add_u32 s53, s53, s3
    s_add_u32 s53, s53, 14155776
    buffer_load_dwordx2 v[20:21], v53, s[20:23], s53 offen sc1
    s_add_u32 s53, s53, 14336
    buffer_load_dwordx2 v[22:23], v53, s[20:23], s53 offen sc1
    s_add_u32 s53, s53, 14336
    buffer_load_dwordx2 v[24:25], v53, s[20:23], s53 offen sc1
    s_add_u32 s53, s53, 14336
    buffer_load_dwordx2 v[26:27], v53, s[20:23], s53 offen sc1
    s_add_u32 s53, s53, 14336
    buffer_load_dwordx2 v[28:29], v53, s[20:23], s53 offen sc1
    s_add_u32 s53, s53, 14336
    buffer_load_dwordx2 v[30:31], v53, s[20:23], s53 offen sc1
    s_add_u32 s53, s53, 14336
    buffer_load_dwordx2 v[32:33], v53, s[20:23], s53 offen sc1
    s_add_u32 s53, s53, 14336
    buffer_load_dwordx2 v[34:35], v53, s[20:23], s53 offen sc1
    s_add_u32 s53, s53, 14336
    buffer_load_dwordx2 v[36:37], v53, s[20:23], s53 offen sc1
    s_add_u32 s53, s53, 14336
    buffer_load_dwordx2 v[38:39], v53, s[20:23], s53 offen sc1
    s_add_u32 s53, s53, 14336
    buffer_load_dwordx2 v[40:41], v53, s[20:23], s53 offen sc1
    s_add_u32 s53, s53, 14336
    buffer_load_dwordx2 v[42:43], v53, s[20:23], s53 offen sc1
    s_add_u32 s53, s53, 14336
    buffer_load_dwordx2 v[44:45], v53, s[20:23], s53 offen sc1
    s_add_u32 s53, s53, 14336
    buffer_load_dwordx2 v[46:47], v53, s[20:23], s53 offen sc1
    s_add_u32 s53, s53, 14336
    buffer_load_dwordx2 v[48:49], v53, s[20:23], s53 offen sc1
    s_add_u32 s53, s53, 14336
    buffer_load_dwordx2 v[50:51], v53, s[20:23], s53 offen sc1
L_tj_29:
    s_waitcnt vmcnt(32)
    s_barrier
    s_add_u32 m0, s51, s52
    s_nop 0
    buffer_load_dwordx4 v18, s[20:23], s48 offen offset:0 sc1 lds
    buffer_load_dwordx4 v18, s[20:23], s48 offen offset:1024 sc1 lds
    buffer_load_dwordx4 v18, s[20:23], s48 offen offset:2048 sc1 lds
    s_mov_b32 exec_hi, 0
    buffer_load_dwordx4 v18, s[20:23], s48 offen offset:3072 sc1 lds
    s_mov_b32 exec_hi, -1
    s_add_u32 s48, s48, 14336
    s_add_u32 s51, s51, 14336
    s_cmp_eq_u32 s51, 153600
    s_cselect_b32 s51, 81920, s51
    s_add_u32 m0, s49, s50
    s_nop 0
    buffer_load_dwordx4 v17, s[20:23], s47 offen offset:0 sc1 lds
    buffer_load_dwordx4 v17, s[20:23], s47 offen offset:1024 sc1 lds
    buffer_load_dwordx4 v17, s[20:23], s47 offen offset:2048 sc1 lds
    buffer_load_dwordx4 v17, s[20:23], s47 offen offset:3072 sc1 lds
    s_add_u32 s47, s47, 16384
    s_add_u32 s49, s49, 16384
    s_cmp_eq_u32 s49, 81920
    s_cselect_b32 s49, 0, s49
    s_waitcnt vmcnt(32)
    s_barrier
    s_add_u32 m0, s51, s52
    s_nop 0
    buffer_load_dwordx4 v18, s[20:23], s48 offen offset:0 sc1 lds
    buffer_load_dwordx4 v18, s[20:23], s48 offen offset:1024 sc1 lds
    buffer_load_dwordx4 v18, s[20:23], s48 offen offset:2048 sc1 lds
    s_mov_b32 exec_hi, 0
    buffer_load_dwordx4 v18, s[20:23], s48 offen offset:3072 sc1 lds
    s_mov_b32 exec_hi, -1
    s_add_u32 s48, s48, 14336
    s_add_u32 s51, s51, 14336
    s_cmp_eq_u32 s51, 153600
    s_cselect_b32 s51, 81920, s51
    s_waitcnt vmcnt(28)
    s_barrier
    s_add_u32 m0, s49, s50
    s_nop 0
    buffer_load_dwordx4 v17, s[20:23], s47 offen offset:0 sc1 lds
    buffer_load_dwordx4 v17, s[20:23], s47 offen offset:1024 sc1 lds
    buffer_load_dwordx4 v17, s[20:23], s47 offen offset:2048 sc1 lds
    buffer_load_dwordx4 v17, s[20:23], s47 offen offset:3072 sc1 lds
    s_add_u32 s47, s47, 16384
    s_add_u32 s49, s49, 16384
    s_cmp_eq_u32 s49, 81920
    s_cselect_b32 s49, 0, s49
    s_add_u32 m0, s51, s52
    s_nop 0
    buffer_load_dwordx4 v18, s[20:23], s48 offen offset:0 sc1 lds
    buffer_load_dwordx4 v18, s[20:23], s48 offen offset:1024 sc1 lds
    buffer_load_dwordx4 v18, s[20:23], s48 offen offset:2048 sc1 lds
    s_mov_b32 exec_hi, 0
    buffer_load_dwordx4 v18, s[20:23], s48 offen offset:3072 sc1 lds
    s_mov_b32 exec_hi, -1
    s_add_u32 s48, s48, 14336
    s_add_u32 s51, s51, 14336
    s_cmp_eq_u32 s51, 153600
    s_cselect_b32 s51, 81920, s51
    s_waitcnt vmcnt(12)
    s_barrier
    s_add_u32 m0, s49, s50
    s_nop 0
    buffer_load_dwordx4 v17, s[20:23], s47 offen offset:0 sc1 lds
    buffer_load_dwordx4 v17, s[20:23], s47 offen offset:1024 sc1 lds
    buffer_load_dwordx4 v17, s[20:23], s47 offen offset:2048 sc1 lds
    buffer_load_dwordx4 v17, s[20:23], s47 offen offset:3072 sc1 lds
    s_add_u32 s47, s47, 16384
    s_add_u32 s49, s49, 16384
    s_cmp_eq_u32 s49, 81920
    s_cselect_b32 s49, 0, s49
    s_add_u32 m0, s51, s52
    s_nop 0
    buffer_load_dwordx4 v18, s[20:23], s48 offen offset:0 sc1 lds
    buffer_load_dwordx4 v18, s[20:23], s48 offen offset:1024 sc1 lds
    buffer_load_dwordx4 v18, s[20:23], s48 offen offset:2048 sc1 lds
    s_mov_b32 exec_hi, 0
    buffer_load_dwordx4 v18, s[20:23], s48 offen offset:3072 sc1 lds
    s_mov_b32 exec_hi, -1
    s_add_u32 s48, s48, 14336
    s_add_u32 s51, s51, 14336
    s_cmp_eq_u32 s51, 153600
    s_cselect_b32 s51, 81920, s51
    s_waitcnt vmcnt(12)
    s_barrier
    s_add_u32 m0, s49, s50
    s_nop 0
    buffer_load_dwordx4 v17, s[20:23], s47 offen offset:0 sc1 lds
    buffer_load_dwordx4 v17, s[20:23], s47 offen offset:1024 sc1 lds
    buffer_load_dwordx4 v17, s[20:23], s47 offen offset:2048 sc1 lds
    buffer_load_dwordx4 v17, s[20:23], s47 offen offset:3072 sc1 lds
    s_add_u32 s47, s47, 16384
    s_add_u32 s49, s49, 16384
    s_cmp_eq_u32 s49, 81920
    s_cselect_b32 s49, 0, s49
    s_cmp_ge_u32 s16, 2
    s_waitcnt vmcnt(32)
    s_cbranch_scc1 L_hv_30
L_hr_31:
    v_max_u32 v3, v21, v23
    v_max3_u32 v3, v3, v25, v27
    v_max3_u32 v3, v3, v29, v31
    v_max3_u32 v3, v3, v33, v35
    v_max3_u32 v3, v3, v37, v39
    v_max3_u32 v3, v3, v41, v43
    v_max3_u32 v3, v3, v45, v47
    v_max3_u32 v3, v3, v49, v51
    v_cmp_eq_u32 vcc, -1, v3
    s_cbranch_vccz L_hv_30
    s_sub_u32 s53, s53, 12288
    buffer_load_dwordx2 v[20:21], v52, s[20:23], s53 offen offset:0 sc1
    buffer_load_dwordx2 v[22:23], v52, s[20:23], s53 offen offset:1024 sc1
    buffer_load_dwordx2 v[24:25], v52, s[20:23], s53 offen offset:2048 sc1
    buffer_load_dwordx2 v[26:27], v52, s[20:23], s53 offen offset:3072 sc1
    s_add_u32 s53, s53, 4096
    buffer_load_dwordx2 v[28:29], v52, s[20:23], s53 offen offset:0 sc1
    buffer_load_dwordx2 v[30:31], v52, s[20:23], s53 offen offset:1024 sc1
    buffer_load_dwordx2 v[32:33], v52, s[20:23], s53 offen offset:2048 sc1
    buffer_load_dwordx2 v[34:35], v52, s[20:23], s53 offen offset:3072 sc1
    s_add_u32 s53, s53, 4096
    buffer_load_dwordx2 v[36:37], v52, s[20:23], s53 offen offset:0 sc1
    buffer_load_dwordx2 v[38:39], v52, s[20:23], s53 offen offset:1024 sc1
    buffer_load_dwordx2 v[40:41], v52, s[20:23], s53 offen offset:2048 sc1
    buffer_load_dwordx2 v[42:43], v52, s[20:23], s53 offen offset:3072 sc1
    s_add_u32 s53, s53, 4096
    buffer_load_dwordx2 v[44:45], v52, s[20:23], s53 offen offset:0 sc1
    buffer_load_dwordx2 v[46:47], v52, s[20:23], s53 offen offset:1024 sc1
    buffer_load_dwordx2 v[48:49], v52, s[20:23], s53 offen offset:2048 sc1
    buffer_load_dwordx2 v[50:51], v52, s[20:23], s53 offen offset:3072 sc1
    s_waitcnt vmcnt(0)
    s_branch L_hr_31
L_hv_30:
    s_cmp_ge_u32 s16, 2
    v_add_f32 v20, v20, v36
    v_add_f32 v21, v21, v37
    v_add_f32 v22, v22, v38
    v_add_f32 v23, v23, v39
    v_add_f32 v24, v24, v40
    v_add_f32 v25, v25, v41
    v_add_f32 v26, v26, v42
    v_add_f32 v27, v27, v43
    v_add_f32 v28, v28, v44
    v_add_f32 v29, v29, v45
    v_add_f32 v30, v30, v46
    v_add_f32 v31, v31, v47
    v_add_f32 v32, v32, v48
    v_add_f32 v33, v33, v49
    v_add_f32 v34, v34, v50
    v_add_f32 v35, v35, v51
    v_add_f32 v20, v20, v28
    v_add_f32 v21, v21, v29
    v_add_f32 v22, v22, v30
    v_add_f32 v23, v23, v31
    v_add_f32 v24, v24, v32
    v_add_f32 v25, v25, v33
    v_add_f32 v26, v26, v34
    v_add_f32 v27, v27, v35
    v_add_f32 v20, v20, v24
    v_add_f32 v21, v21, v25
    v_add_f32 v22, v22, v26
    v_add_f32 v23, v23, v27
    v_add_f32 v20, v20, v22
    v_add_f32 v21, v21, v23
    s_cbranch_scc0 L_cw_32
    v_add_u32 v3, 161792, v52
    ds_write_b64 v3, v[20:21]
    s_branch L_tw_33
L_cw_32:
    v_mul_f32 v20, 0x3a800000, v20
    v_mul_f32 v21, 0x3a800000, v21
    v_fma_f32 v21, -v20, v20, v21
    v_max_f32 v21, 0, v21
    v_add_f32 v21, 0x3727c5ac, v21
    v_rsq_f32 v22, v21
    v_sub_f32 v24, 0, v20
    v_lshlrev_b32 v3, 1, v52
    v_mul_f32 v27, v21, v22
    v_mul_f32 v26, 0xc0135761, v22
    v_mul_f32 v25, v22, v22
    v_mul_f32 v25, v25, v22
    v_mul_f32 v25, 0xbdd2d3e8, v25
    v_add_u32 v3, 157696, v3
    v_lshrrev_b32 v4, 1, v52
    v_add_u32 v4, 159744, v4
    ds_write_b128 v3, v[24:27]
    ds_write_b32 v4, v24
    ds_write_b32 v4, v25 offset:512
    ds_write_b32 v4, v26 offset:1024
    ds_write_b32 v4, v27 offset:1536
L_tw_33:
    s_waitcnt lgkmcnt(0)
    s_mov_b32 s15, 4
L_ll_34:
    s_waitcnt vmcnt(8)
    s_barrier
    s_add_u32 m0, s51, s52
    s_nop 0
    buffer_load_dwordx4 v18, s[20:23], s48 offen offset:0 sc1 lds
    buffer_load_dwordx4 v18, s[20:23], s48 offen offset:1024 sc1 lds
    buffer_load_dwordx4 v18, s[20:23], s48 offen offset:2048 sc1 lds
    s_mov_b32 exec_hi, 0
    buffer_load_dwordx4 v18, s[20:23], s48 offen offset:3072 sc1 lds
    s_mov_b32 exec_hi, -1
    s_add_u32 s48, s48, 14336
    s_add_u32 s51, s51, 14336
    s_cmp_eq_u32 s51, 153600
    s_cselect_b32 s51, 81920, s51
    s_add_u32 m0, s49, s50
    s_nop 0
    buffer_load_dwordx4 v17, s[20:23], s47 offen offset:0 sc1 lds
    buffer_load_dwordx4 v17, s[20:23], s47 offen offset:1024 sc1 lds
    buffer_load_dwordx4 v17, s[20:23], s47 offen offset:2048 sc1 lds
    buffer_load_dwordx4 v17, s[20:23], s47 offen offset:3072 sc1 lds
    s_add_u32 s47, s47, 16384
    s_add_u32 s49, s49, 16384
    s_cmp_eq_u32 s49, 81920
    s_cselect_b32 s49, 0, s49
    s_sub_u32 s15, s15, 1
    s_cmp_lg_u32 s15, 0
    s_nop 7
    s_cbranch_scc1 L_ll_34
    s_waitcnt vmcnt(8)
    s_barrier
    s_add_u32 s48, s48, 157696
    s_add_u32 m0, s51, s52
    s_nop 0
    buffer_load_dwordx4 v18, s[20:23], s48 offen offset:0 sc1 lds
    buffer_load_dwordx4 v18, s[20:23], s48 offen offset:1024 sc1 lds
    buffer_load_dwordx4 v18, s[20:23], s48 offen offset:2048 sc1 lds
    s_mov_b32 exec_hi, 0
    buffer_load_dwordx4 v18, s[20:23], s48 offen offset:3072 sc1 lds
    s_mov_b32 exec_hi, -1
    s_add_u32 s48, s48, 14336
    s_add_u32 s51, s51, 14336
    s_cmp_eq_u32 s51, 153600
    s_cselect_b32 s51, 81920, s51
    s_sub_u32 s47, s47, 262144
    s_waitcnt vmcnt(4)
    s_barrier
    s_barrier
    s_add_u32 m0, s51, s52
    s_nop 0
    buffer_load_dwordx4 v18, s[20:23], s48 offen offset:0 sc1 lds
    buffer_load_dwordx4 v18, s[20:23], s48 offen offset:1024 sc1 lds
    buffer_load_dwordx4 v18, s[20:23], s48 offen offset:2048 sc1 lds
    s_mov_b32 exec_hi, 0
    buffer_load_dwordx4 v18, s[20:23], s48 offen offset:3072 sc1 lds
    s_mov_b32 exec_hi, -1
    s_add_u32 s48, s48, 14336
    s_add_u32 s51, s51, 14336
    s_cmp_eq_u32 s51, 153600
    s_cselect_b32 s51, 81920, s51
    s_add_u32 m0, s51, s52
    s_nop 0
    buffer_load_dwordx4 v18, s[20:23], s48 offen offset:0 sc1 lds
    buffer_load_dwordx4 v18, s[20:23], s48 offen offset:1024 sc1 lds
    buffer_load_dwordx4 v18, s[20:23], s48 offen offset:2048 sc1 lds
    s_mov_b32 exec_hi, 0
    buffer_load_dwordx4 v18, s[20:23], s48 offen offset:3072 sc1 lds
    s_mov_b32 exec_hi, -1
    s_add_u32 s48, s48, 14336
    s_add_u32 s51, s51, 14336
    s_cmp_eq_u32 s51, 153600
    s_cselect_b32 s51, 81920, s51
    s_add_u32 m0, s51, s52
    s_nop 0
    buffer_load_dwordx4 v18, s[20:23], s48 offen offset:0 sc1 lds
    buffer_load_dwordx4 v18, s[20:23], s48 offen offset:1024 sc1 lds
    buffer_load_dwordx4 v18, s[20:23], s48 offen offset:2048 sc1 lds
    s_mov_b32 exec_hi, 0
    buffer_load_dwordx4 v18, s[20:23], s48 offen offset:3072 sc1 lds
    s_mov_b32 exec_hi, -1
    s_add_u32 s48, s48, 14336
    s_add_u32 s51, s51, 14336
    s_cmp_eq_u32 s51, 153600
    s_cselect_b32 s51, 81920, s51
    s_add_u32 m0, s51, s52
    s_nop 0
    buffer_load_dwordx4 v18, s[20:23], s48 offen offset:0 sc1 lds
    buffer_load_dwordx4 v18, s[20:23], s48 offen offset:1024 sc1 lds
    buffer_load_dwordx4 v18, s[20:23], s48 offen offset:2048 sc1 lds
    s_mov_b32 exec_hi, 0
    buffer_load_dwordx4 v18, s[20:23], s48 offen offset:3072 sc1 lds
    s_mov_b32 exec_hi, -1
    s_add_u32 s48, s48, 14336
    s_add_u32 s51, s51, 14336
    s_cmp_eq_u32 s51, 153600
    s_cselect_b32 s51, 81920, s51
    s_waitcnt vmcnt(16)
    s_barrier
    s_waitcnt vmcnt(12)
    s_barrier
    s_sub_u32 s48, s48, 229376
    s_add_u32 m0, s51, s52
    s_nop 0
    buffer_load_dwordx4 v18, s[20:23], s48 offen offset:0 sc1 lds
    buffer_load_dwordx4 v18, s[20:23], s48 offen offset:1024 sc1 lds
    buffer_load_dwordx4 v18, s[20:23], s48 offen offset:2048 sc1 lds
    s_mov_b32 exec_hi, 0
    buffer_load_dwordx4 v18, s[20:23], s48 offen offset:3072 sc1 lds
    s_mov_b32 exec_hi, -1
    s_add_u32 s48, s48, 14336
    s_add_u32 s51, s51, 14336
    s_cmp_eq_u32 s51, 153600
    s_cselect_b32 s51, 81920, s51
    s_add_u32 m0, s49, s50
    s_nop 0
    buffer_load_dwordx4 v17, s[20:23], s47 offen offset:0 sc1 lds
    buffer_load_dwordx4 v17, s[20:23], s47 offen offset:1024 sc1 lds
    buffer_load_dwordx4 v17, s[20:23], s47 offen offset:2048 sc1 lds
    buffer_load_dwordx4 v17, s[20:23], s47 offen offset:3072 sc1 lds
    s_add_u32 s47, s47, 16384
    s_add_u32 s49, s49, 16384
    s_cmp_eq_u32 s49, 81920
    s_cselect_b32 s49, 0, s49
    s_waitcnt vmcnt(16)
    s_barrier
    s_add_u32 m0, s51, s52
    s_nop 0
    buffer_load_dwordx4 v18, s[20:23], s48 offen offset:0 sc1 lds
    buffer_load_dwordx4 v18, s[20:23], s48 offen offset:1024 sc1 lds
    buffer_load_dwordx4 v18, s[20:23], s48 offen offset:2048 sc1 lds
    s_mov_b32 exec_hi, 0
    buffer_load_dwordx4 v18, s[20:23], s48 offen offset:3072 sc1 lds
    s_mov_b32 exec_hi, -1
    s_add_u32 s48, s48, 14336
    s_add_u32 s51, s51, 14336
    s_cmp_eq_u32 s51, 153600
    s_cselect_b32 s51, 81920, s51
    s_add_u32 m0, s49, s50
    s_nop 0
    buffer_load_dwordx4 v17, s[20:23], s47 offen offset:0 sc1 lds
    buffer_load_dwordx4 v17, s[20:23], s47 offen offset:1024 sc1 lds
    buffer_load_dwordx4 v17, s[20:23], s47 offen offset:2048 sc1 lds
    buffer_load_dwordx4 v17, s[20:23], s47 offen offset:3072 sc1 lds
    s_add_u32 s47, s47, 16384
    s_add_u32 s49, s49, 16384
    s_cmp_eq_u32 s49, 81920
    s_cselect_b32 s49, 0, s49
    s_waitcnt vmcnt(20)
    s_barrier
    s_add_u32 m0, s51, s52
    s_nop 0
    buffer_load_dwordx4 v18, s[20:23], s48 offen offset:0 sc1 lds
    buffer_load_dwordx4 v18, s[20:23], s48 offen offset:1024 sc1 lds
    buffer_load_dwordx4 v18, s[20:23], s48 offen offset:2048 sc1 lds
    s_mov_b32 exec_hi, 0
    buffer_load_dwordx4 v18, s[20:23], s48 offen offset:3072 sc1 lds
    s_mov_b32 exec_hi, -1
    s_add_u32 s48, s48, 14336
    s_add_u32 s51, s51, 14336
    s_cmp_eq_u32 s51, 153600
    s_cselect_b32 s51, 81920, s51
    s_waitcnt vmcnt(20)
    s_barrier
    s_add_u32 m0, s49, s50
    s_nop 0
    buffer_load_dwordx4 v17, s[20:23], s47 offen offset:0 sc1 lds
    buffer_load_dwordx4 v17, s[20:23], s47 offen offset:1024 sc1 lds
    buffer_load_dwordx4 v17, s[20:23], s47 offen offset:2048 sc1 lds
    buffer_load_dwordx4 v17, s[20:23], s47 offen offset:3072 sc1 lds
    s_add_u32 s47, s47, 16384
    s_add_u32 s49, s49, 16384
    s_cmp_eq_u32 s49, 81920
    s_cselect_b32 s49, 0, s49
    s_add_u32 m0, s51, s52
    s_nop 0
    buffer_load_dwordx4 v18, s[20:23], s48 offen offset:0 sc1 lds
    buffer_load_dwordx4 v18, s[20:23], s48 offen offset:1024 sc1 lds
    buffer_load_dwordx4 v18, s[20:23], s48 offen offset:2048 sc1 lds
    s_mov_b32 exec_hi, 0
    buffer_load_dwordx4 v18, s[20:23], s48 offen offset:3072 sc1 lds
    s_mov_b32 exec_hi, -1
    s_add_u32 s48, s48, 14336
    s_add_u32 s51, s51, 14336
    s_cmp_eq_u32 s51, 153600
    s_cselect_b32 s51, 81920, s51
    s_waitcnt vmcnt(20)
    s_barrier
    s_add_u32 m0, s49, s50
    s_nop 0
    buffer_load_dwordx4 v17, s[20:23], s47 offen offset:0 sc1 lds
    buffer_load_dwordx4 v17, s[20:23], s47 offen offset:1024 sc1 lds
    buffer_load_dwordx4 v17, s[20:23], s47 offen offset:2048 sc1 lds
    buffer_load_dwordx4 v17, s[20:23], s47 offen offset:3072 sc1 lds
    s_add_u32 s47, s47, 16384
    s_add_u32 s49, s49, 16384
    s_cmp_eq_u32 s49, 81920
    s_cselect_b32 s49, 0, s49
    s_add_u32 m0, s51, s52
    s_nop 0
    buffer_load_dwordx4 v18, s[20:23], s48 offen offset:0 sc1 lds
    buffer_load_dwordx4 v18, s[20:23], s48 offen offset:1024 sc1 lds
    buffer_load_dwordx4 v18, s[20:23], s48 offen offset:2048 sc1 lds
    s_mov_b32 exec_hi, 0
    buffer_load_dwordx4 v18, s[20:23], s48 offen offset:3072 sc1 lds
    s_mov_b32 exec_hi, -1
    s_add_u32 s48, s48, 14336
    s_add_u32 s51, s51, 14336
    s_cmp_eq_u32 s51, 153600
    s_cselect_b32 s51, 81920, s51
    s_waitcnt vmcnt(20)
    s_barrier
    s_add_u32 m0, s49, s50
    s_nop 0
    buffer_load_dwordx4 v17, s[20:23], s47 offen offset:0 sc1 lds
    buffer_load_dwordx4 v17, s[20:23], s47 offen offset:1024 sc1 lds
    buffer_load_dwordx4 v17, s[20:23], s47 offen offset:2048 sc1 lds
    buffer_load_dwordx4 v17, s[20:23], s47 offen offset:3072 sc1 lds
    s_add_u32 s47, s47, 16384
    s_add_u32 s49, s49, 16384
    s_cmp_eq_u32 s49, 81920
    s_cselect_b32 s49, 0, s49
    s_waitcnt vmcnt(16)
    s_barrier
    s_add_u32 m0, s51, s52
    s_nop 0
    buffer_load_dwordx4 v18, s[20:23], s48 offen offset:0 sc1 lds
    buffer_load_dwordx4 v18, s[20:23], s48 offen offset:1024 sc1 lds
    buffer_load_dwordx4 v18, s[20:23], s48 offen offset:2048 sc1 lds
    s_mov_b32 exec_hi, 0
    buffer_load_dwordx4 v18, s[20:23], s48 offen offset:3072 sc1 lds
    s_mov_b32 exec_hi, -1
    s_add_u32 s48, s48, 14336
    s_add_u32 s51, s51, 14336
    s_cmp_eq_u32 s51, 153600
    s_cselect_b32 s51, 81920, s51
    s_add_u32 m0, s49, s50
    s_nop 0
    buffer_load_dwordx4 v17, s[20:23], s47 offen offset:0 sc1 lds
    buffer_load_dwordx4 v17, s[20:23], s47 offen offset:1024 sc1 lds
    buffer_load_dwordx4 v17, s[20:23], s47 offen offset:2048 sc1 lds
    buffer_load_dwordx4 v17, s[20:23], s47 offen offset:3072 sc1 lds
    s_add_u32 s47, s47, 16384
    s_add_u32 s49, s49, 16384
    s_cmp_eq_u32 s49, 81920
    s_cselect_b32 s49, 0, s49
    s_waitcnt vmcnt(16)
    s_barrier
    s_add_u32 m0, s51, s52
    s_nop 0
    buffer_load_dwordx4 v18, s[20:23], s48 offen offset:0 sc1 lds
    buffer_load_dwordx4 v18, s[20:23], s48 offen offset:1024 sc1 lds
    buffer_load_dwordx4 v18, s[20:23], s48 offen offset:2048 sc1 lds
    s_mov_b32 exec_hi, 0
    buffer_load_dwordx4 v18, s[20:23], s48 offen offset:3072 sc1 lds
    s_mov_b32 exec_hi, -1
    s_add_u32 s48, s48, 14336
    s_add_u32 s51, s51, 14336
    s_cmp_eq_u32 s51, 153600
    s_cselect_b32 s51, 81920, s51
    s_add_u32 m0, s49, s50
    s_nop 0
    buffer_load_dwordx4 v17, s[20:23], s47 offen offset:0 sc1 lds
    buffer_load_dwordx4 v17, s[20:23], s47 offen offset:1024 sc1 lds
    buffer_load_dwordx4 v17, s[20:23], s47 offen offset:2048 sc1 lds
    buffer_load_dwordx4 v17, s[20:23], s47 offen offset:3072 sc1 lds
    s_add_u32 s47, s47, 16384
    s_add_u32 s49, s49, 16384
    s_cmp_eq_u32 s49, 81920
    s_cselect_b32 s49, 0, s49
    s_waitcnt vmcnt(16)
    s_barrier
    s_add_u32 m0, s51, s52
    s_nop 0
    buffer_load_dwordx4 v18, s[20:23], s48 offen offset:0 sc1 lds
    buffer_load_dwordx4 v18, s[20:23], s48 offen offset:1024 sc1 lds
    buffer_load_dwordx4 v18, s[20:23], s48 offen offset:2048 sc1 lds
    s_mov_b32 exec_hi, 0
    buffer_load_dwordx4 v18, s[20:23], s48 offen offset:3072 sc1 lds
    s_mov_b32 exec_hi, -1
    s_add_u32 s48, s48, 14336
    s_add_u32 s51, s51, 14336
    s_cmp_eq_u32 s51, 153600
    s_cselect_b32 s51, 81920, s51
    s_waitcnt vmcnt(12)
    s_barrier
    s_add_u32 m0, s49, s50
    s_nop 0
    buffer_load_dwordx4 v17, s[20:23], s47 offen offset:0 sc1 lds
    buffer_load_dwordx4 v17, s[20:23], s47 offen offset:1024 sc1 lds
    buffer_load_dwordx4 v17, s[20:23], s47 offen offset:2048 sc1 lds
    buffer_load_dwordx4 v17, s[20:23], s47 offen offset:3072 sc1 lds
    s_add_u32 s47, s47, 16384
    s_add_u32 s49, s49, 16384
    s_cmp_eq_u32 s49, 81920
    s_cselect_b32 s49, 0, s49
    s_add_u32 m0, s51, s52
    s_nop 0
    buffer_load_dwordx4 v18, s[20:23], s48 offen offset:0 sc1 lds
    buffer_load_dwordx4 v18, s[20:23], s48 offen offset:1024 sc1 lds
    buffer_load_dwordx4 v18, s[20:23], s48 offen offset:2048 sc1 lds
    s_mov_b32 exec_hi, 0
    buffer_load_dwordx4 v18, s[20:23], s48 offen offset:3072 sc1 lds
    s_mov_b32 exec_hi, -1
    s_add_u32 s48, s48, 14336
    s_add_u32 s51, s51, 14336
    s_cmp_eq_u32 s51, 153600
    s_cselect_b32 s51, 81920, s51
    s_waitcnt vmcnt(12)
    s_barrier
    s_add_u32 m0, s49, s50
    s_nop 0
    buffer_load_dwordx4 v17, s[20:23], s47 offen offset:0 sc1 lds
    buffer_load_dwordx4 v17, s[20:23], s47 offen offset:1024 sc1 lds
    buffer_load_dwordx4 v17, s[20:23], s47 offen offset:2048 sc1 lds
    buffer_load_dwordx4 v17, s[20:23], s47 offen offset:3072 sc1 lds
    s_add_u32 s47, s47, 16384
    s_add_u32 s49, s49, 16384
    s_cmp_eq_u32 s49, 81920
    s_cselect_b32 s49, 0, s49
    s_add_u32 m0, s51, s52
    s_nop 0
    buffer_load_dwordx4 v18, s[20:23], s48 offen offset:0 sc1 lds
    buffer_load_dwordx4 v18, s[20:23], s48 offen offset:1024 sc1 lds
    buffer_load_dwordx4 v18, s[20:23], s48 offen offset:2048 sc1 lds
    s_mov_b32 exec_hi, 0
    buffer_load_dwordx4 v18, s[20:23], s48 offen offset:3072 sc1 lds
    s_mov_b32 exec_hi, -1
    s_add_u32 s48, s48, 14336
    s_add_u32 s51, s51, 14336
    s_cmp_eq_u32 s51, 153600
    s_cselect_b32 s51, 81920, s51
    s_waitcnt vmcnt(12)
    s_barrier
    s_add_u32 m0, s49, s50
    s_nop 0
    buffer_load_dwordx4 v17, s[20:23], s47 offen offset:0 sc1 lds
    buffer_load_dwordx4 v17, s[20:23], s47 offen offset:1024 sc1 lds
    buffer_load_dwordx4 v17, s[20:23], s47 offen offset:2048 sc1 lds
    buffer_load_dwordx4 v17, s[20:23], s47 offen offset:3072 sc1 lds
    s_add_u32 s47, s47, 16384
    s_add_u32 s49, s49, 16384
    s_cmp_eq_u32 s49, 81920
    s_cselect_b32 s49, 0, s49
    s_waitcnt vmcnt(8)
    s_barrier
    s_add_u32 m0, s51, s52
    s_nop 0
    buffer_load_dwordx4 v18, s[20:23], s48 offen offset:0 sc1 lds
    buffer_load_dwordx4 v18, s[20:23], s48 offen offset:1024 sc1 lds
    buffer_load_dwordx4 v18, s[20:23], s48 offen offset:2048 sc1 lds
    s_mov_b32 exec_hi, 0
    buffer_load_dwordx4 v18, s[20:23], s48 offen offset:3072 sc1 lds
    s_mov_b32 exec_hi, -1
    s_add_u32 s48, s48, 14336
    s_add_u32 s51, s51, 14336
    s_cmp_eq_u32 s51, 153600
    s_cselect_b32 s51, 81920, s51
    s_add_u32 m0, s49, s50
    s_nop 0
    buffer_load_dwordx4 v17, s[20:23], s47 offen offset:0 sc1 lds
    buffer_load_dwordx4 v17, s[20:23], s47 offen offset:1024 sc1 lds
    buffer_load_dwordx4 v17, s[20:23], s47 offen offset:2048 sc1 lds
    buffer_load_dwordx4 v17, s[20:23], s47 offen offset:3072 sc1 lds
    s_add_u32 s47, s47, 16384
    s_add_u32 s49, s49, 16384
    s_cmp_eq_u32 s49, 81920
    s_cselect_b32 s49, 0, s49
    s_waitcnt vmcnt(8)
    s_barrier
    s_lshl_b32 s53, s44, 9
    s_add_u32 s53, s53, 46170112
    v_and_b32 v3, 15, v1
    v_lshlrev_b32 v3, 2, v3
    buffer_load_dword v20, v3, s[20:23], s53 offen sc1
    s_lshl_b32 s47, s43, 19
    s_add_u32 s47, s47, 67108864
    s_add_u32 m0, s49, s50
    s_nop 0
    buffer_load_dwordx4 v17, s[20:23], s47 offen offset:0 sc1 lds
    buffer_load_dwordx4 v17, s[20:23], s47 offen offset:1024 sc1 lds
    buffer_load_dwordx4 v17, s[20:23], s47 offen offset:2048 sc1 lds
    buffer_load_dwordx4 v17, s[20:23], s47 offen offset:3072 sc1 lds
    s_add_u32 s47, s47, 16384
    s_add_u32 s49, s49, 16384
    s_cmp_eq_u32 s49, 81920
    s_cselect_b32 s49, 0, s49
    s_add_u32 m0, s49, s50
    s_nop 0
    buffer_load_dwordx4 v17, s[20:23], s47 offen offset:0 sc1 lds
    buffer_load_dwordx4 v17, s[20:23], s47 offen offset:1024 sc1 lds
    buffer_load_dwordx4 v17, s[20:23], s47 offen offset:2048 sc1 lds
    buffer_load_dwordx4 v17, s[20:23], s47 offen offset:3072 sc1 lds
    s_add_u32 s47, s47, 16384
    s_add_u32 s49, s49, 16384
    s_cmp_eq_u32 s49, 81920
    s_cselect_b32 s49, 0, s49
    s_waitcnt vmcnt(9)
    s_barrier
    s_barrier
    s_waitcnt vmcnt(8)
L_zp_35:
    v_cmp_ne_u32 vcc, 0, v20
    s_cbranch_vccz L_zp_35x
    s_sleep 2
    buffer_load_dword v20, v3, s[20:23], s53 offen sc1
    s_waitcnt vmcnt(0)
    s_branch L_zp_35
L_zp_35x:
    s_mul_i32 s48, s44, 458752
    s_add_u32 s48, s48, 22020096
    s_add_u32 m0, s51, s52
    s_nop 0
    buffer_load_dwordx4 v18, s[20:23], s48 offen offset:0 sc1 lds
    buffer_load_dwordx4 v18, s[20:23], s48 offen offset:1024 sc1 lds
    buffer_load_dwordx4 v18, s[20:23], s48 offen offset:2048 sc1 lds
    s_mov_b32 exec_hi, 0
    buffer_load_dwordx4 v18, s[20:23], s48 offen offset:3072 sc1 lds
    s_mov_b32 exec_hi, -1
    s_add_u32 s48, s48, 14336
    s_add_u32 s51, s51, 14336
    s_cmp_eq_u32 s51, 153600
    s_cselect_b32 s51, 81920, s51
    s_add_u32 m0, s51, s52
    s_nop 0
    buffer_load_dwordx4 v18, s[20:23], s48 offen offset:0 sc1 lds
    buffer_load_dwordx4 v18, s[20:23], s48 offen offset:1024 sc1 lds
    buffer_load_dwordx4 v18, s[20:23], s48 offen offset:2048 sc1 lds
    s_mov_b32 exec_hi, 0
    buffer_load_dwordx4 v18, s[20:23], s48 offen offset:3072 sc1 lds
    s_mov_b32 exec_hi, -1
    s_add_u32 s48, s48, 14336
    s_add_u32 s51, s51, 14336
    s_cmp_eq_u32 s51, 153600
    s_cselect_b32 s51, 81920, s51
    s_add_u32 m0, s51, s52
    s_nop 0
    buffer_load_dwordx4 v18, s[20:23], s48 offen offset:0 sc1 lds
    buffer_load_dwordx4 v18, s[20:23], s48 offen offset:1024 sc1 lds
    buffer_load_dwordx4 v18, s[20:23], s48 offen offset:2048 sc1 lds
    s_mov_b32 exec_hi, 0
    buffer_load_dwordx4 v18, s[20:23], s48 offen offset:3072 sc1 lds
    s_mov_b32 exec_hi, -1
    s_add_u32 s48, s48, 14336
    s_add_u32 s51, s51, 14336
    s_cmp_eq_u32 s51, 153600
    s_cselect_b32 s51, 81920, s51
    s_add_u32 m0, s49, s50
    s_nop 0
    buffer_load_dwordx4 v17, s[20:23], s47 offen offset:0 sc1 lds
    buffer_load_dwordx4 v17, s[20:23], s47 offen offset:1024 sc1 lds
    buffer_load_dwordx4 v17, s[20:23], s47 offen offset:2048 sc1 lds
    buffer_load_dwordx4 v17, s[20:23], s47 offen offset:3072 sc1 lds
    s_add_u32 s47, s47, 16384
    s_add_u32 s49, s49, 16384
    s_cmp_eq_u32 s49, 81920
    s_cselect_b32 s49, 0, s49
    s_add_u32 m0, s51, s52
    s_nop 0
    buffer_load_dwordx4 v18, s[20:23], s48 offen offset:0 sc1 lds
    buffer_load_dwordx4 v18, s[20:23], s48 offen offset:1024 sc1 lds
    buffer_load_dwordx4 v18, s[20:23], s48 offen offset:2048 sc1 lds
    s_mov_b32 exec_hi, 0
    buffer_load_dwordx4 v18, s[20:23], s48 offen offset:3072 sc1 lds
    s_mov_b32 exec_hi, -1
    s_add_u32 s48, s48, 14336
    s_add_u32 s51, s51, 14336
    s_cmp_eq_u32 s51, 153600
    s_cselect_b32 s51, 81920, s51
    s_add_u32 m0, s49, s50
    s_nop 0
    buffer_load_dwordx4 v17, s[20:23], s47 offen offset:0 sc1 lds
    buffer_load_dwordx4 v17, s[20:23], s47 offen offset:1024 sc1 lds
    buffer_load_dwordx4 v17, s[20:23], s47 offen offset:2048 sc1 lds
    buffer_load_dwordx4 v17, s[20:23], s47 offen offset:3072 sc1 lds
    s_add_u32 s47, s47, 16384
    s_add_u32 s49, s49, 16384
    s_cmp_eq_u32 s49, 81920
    s_cselect_b32 s49, 0, s49
    s_add_u32 m0, s51, s52
    s_nop 0
    buffer_load_dwordx4 v18, s[20:23], s48 offen offset:0 sc1 lds
    buffer_load_dwordx4 v18, s[20:23], s48 offen offset:1024 sc1 lds
    buffer_load_dwordx4 v18, s[20:23], s48 offen offset:2048 sc1 lds
    s_mov_b32 exec_hi, 0
    buffer_load_dwordx4 v18, s[20:23], s48 offen offset:3072 sc1 lds
    s_mov_b32 exec_hi, -1
    s_add_u32 s48, s48, 14336
    s_add_u32 s51, s51, 14336
    s_cmp_eq_u32 s51, 153600
    s_cselect_b32 s51, 81920, s51
    s_add_u32 m0, s49, s50
    s_nop 0
    buffer_load_dwordx4 v17, s[20:23], s47 offen offset:0 sc1 lds
    buffer_load_dwordx4 v17, s[20:23], s47 offen offset:1024 sc1 lds
    buffer_load_dwordx4 v17, s[20:23], s47 offen offset:2048 sc1 lds
    buffer_load_dwordx4 v17, s[20:23], s47 offen offset:3072 sc1 lds
    s_add_u32 s47, s47, 16384
    s_add_u32 s49, s49, 16384
    s_cmp_eq_u32 s49, 81920
    s_cselect_b32 s49, 0, s49
    s_waitcnt vmcnt(28)
    s_barrier
    s_waitcnt vmcnt(24)
    s_barrier
    s_add_u32 m0, s51, s52
    s_nop 0
    buffer_load_dwordx4 v18, s[20:23], s48 offen offset:0 sc1 lds
    buffer_load_dwordx4 v18, s[20:23], s48 offen offset:1024 sc1 lds
    buffer_load_dwordx4 v18, s[20:23], s48 offen offset:2048 sc1 lds
    s_mov_b32 exec_hi, 0
    buffer_load_dwordx4 v18, s[20:23], s48 offen offset:3072 sc1 lds
    s_mov_b32 exec_hi, -1
    s_add_u32 s48, s48, 14336
    s_add_u32 s51, s51, 14336
    s_cmp_eq_u32 s51, 153600
    s_cselect_b32 s51, 81920, s51
    s_add_u32 m0, s49, s50
    s_nop 0
    buffer_load_dwordx4 v17, s[20:23], s47 offen offset:0 sc1 lds
    buffer_load_dwordx4 v17, s[20:23], s47 offen offset:1024 sc1 lds
    buffer_load_dwordx4 v17, s[20:23], s47 offen offset:2048 sc1 lds
    buffer_load_dwordx4 v17, s[20:23], s47 offen offset:3072 sc1 lds
    s_add_u32 s47, s47, 16384
    s_add_u32 s49, s49, 16384
    s_cmp_eq_u32 s49, 81920
    s_cselect_b32 s49, 0, s49
    s_waitcnt vmcnt(24)
    s_barrier
    s_add_u32 m0, s51, s52
    s_nop 0
    buffer_load_dwordx4 v18, s[20:23], s48 offen offset:0 sc1 lds
    buffer_load_dwordx4 v18, s[20:23], s48 offen offset:1024 sc1 lds
    buffer_load_dwordx4 v18, s[20:23], s48 offen offset:2048 sc1 lds
    s_mov_b32 exec_hi, 0
    buffer_load_dwordx4 v18, s[20:23], s48 offen offset:3072 sc1 lds
    s_mov_b32 exec_hi, -1
    s_add_u32 s48, s48, 14336
    s_add_u32 s51, s51, 14336
    s_cmp_eq_u32 s51, 153600
    s_cselect_b32 s51, 81920, s51
    s_add_u32 m0, s49, s50
    s_nop 0
    buffer_load_dwordx4 v17, s[20:23], s47 offen offset:0 sc1 lds
    buffer_load_dwordx4 v17, s[20:23], s47 offen offset:1024 sc1 lds
    buffer_load_dwordx4 v17, s[20:23], s47 offen offset:2048 sc1 lds
    buffer_load_dwordx4 v17, s[20:23], s47 offen offset:3072 sc1 lds
    s_add_u32 s47, s47, 16384
    s_add_u32 s49, s49, 16384
    s_cmp_eq_u32 s49, 81920
    s_cselect_b32 s49, 0, s49
    s_waitcnt vmcnt(24)
    s_barrier
    s_add_u32 m0, s51, s52
    s_nop 0
    buffer_load_dwordx4 v18, s[20:23], s48 offen offset:0 sc1 lds
    buffer_load_dwordx4 v18, s[20:23], s48 offen offset:1024 sc1 lds
    buffer_load_dwordx4 v18, s[20:23], s48 offen offset:2048 sc1 lds
    s_mov_b32 exec_hi, 0
    buffer_load_dwordx4 v18, s[20:23], s48 offen offset:3072 sc1 lds
    s_mov_b32 exec_hi, -1
    s_add_u32 s48, s48, 14336
    s_add_u32 s51, s51, 14336
    s_cmp_eq_u32 s51, 153600
    s_cselect_b32 s51, 81920, s51
    s_waitcnt vmcnt(20)
    s_barrier
    s_add_u32 m0, s49, s50
    s_nop 0
    buffer_load_dwordx4 v17, s[20:23], s47 offen offset:0 sc1 lds
    buffer_load_dwordx4 v17, s[20:23], s47 offen offset:1024 sc1 lds
    buffer_load_dwordx4 v17, s[20:23], s47 offen offset:2048 sc1 lds
    buffer_load_dwordx4 v17, s[20:23], s47 offen offset:3072 sc1 lds
    s_add_u32 s47, s47, 16384
    s_add_u32 s49, s49, 16384
    s_cmp_eq_u32 s49, 81920
    s_cselect_b32 s49, 0, s49
    s_add_u32 m0, s51, s52
    s_nop 0
    buffer_load_dwordx4 v18, s[20:23], s48 offen offset:0 sc1 lds
    buffer_load_dwordx4 v18, s[20:23], s48 offen offset:1024 sc1 lds
    buffer_load_dwordx4 v18, s[20:23], s48 offen offset:2048 sc1 lds
    s_mov_b32 exec_hi, 0
    buffer_load_dwordx4 v18, s[20:23], s48 offen offset:3072 sc1 lds
    s_mov_b32 exec_hi, -1
    s_add_u32 s48, s48, 14336
    s_add_u32 s51, s51, 14336
    s_cmp_eq_u32 s51, 153600
    s_cselect_b32 s51, 81920, s51
    s_waitcnt vmcnt(20)
    s_barrier
    s_add_u32 m0, s49, s50
    s_nop 0
    buffer_load_dwordx4 v17, s[20:23], s47 offen offset:0 sc1 lds
    buffer_load_dwordx4 v17, s[20:23], s47 offen offset:1024 sc1 lds
    buffer_load_dwordx4 v17, s[20:23], s47 offen offset:2048 sc1 lds
    buffer_load_dwordx4 v17, s[20:23], s47 offen offset:3072 sc1 lds
    s_add_u32 s47, s47, 16384
    s_add_u32 s49, s49, 16384
    s_cmp_eq_u32 s49, 81920
    s_cselect_b32 s49, 0, s49
    s_add_u32 m0, s51, s52
    s_nop 0
    buffer_load_dwordx4 v18, s[20:23], s48 offen offset:0 sc1 lds
    buffer_load_dwordx4 v18, s[20:23], s48 offen offset:1024 sc1 lds
    buffer_load_dwordx4 v18, s[20:23], s48 offen offset:2048 sc1 lds
    s_mov_b32 exec_hi, 0
    buffer_load_dwordx4 v18, s[20:23], s48 offen offset:3072 sc1 lds
    s_mov_b32 exec_hi, -1
    s_add_u32 s48, s48, 14336
    s_add_u32 s51, s51, 14336
    s_cmp_eq_u32 s51, 153600
    s_cselect_b32 s51, 81920, s51
    s_waitcnt vmcnt(20)
    s_barrier
    s_add_u32 m0, s49, s50
    s_nop 0
    buffer_load_dwordx4 v17, s[20:23], s47 offen offset:0 sc1 lds
    buffer_load_dwordx4 v17, s[20:23], s47 offen offset:1024 sc1 lds
    buffer_load_dwordx4 v17, s[20:23], s47 offen offset:2048 sc1 lds
    buffer_load_dwordx4 v17, s[20:23], s47 offen offset:3072 sc1 lds
    s_add_u32 s47, s47, 16384
    s_add_u32 s49, s49, 16384
    s_cmp_eq_u32 s49, 81920
    s_cselect_b32 s49, 0, s49
    s_waitcnt vmcnt(16)
    s_barrier
    s_add_u32 m0, s51, s52
    s_nop 0
    buffer_load_dwordx4 v18, s[20:23], s48 offen offset:0 sc1 lds
    buffer_load_dwordx4 v18, s[20:23], s48 offen offset:1024 sc1 lds
    buffer_load_dwordx4 v18, s[20:23], s48 offen offset:2048 sc1 lds
    s_mov_b32 exec_hi, 0
    buffer_load_dwordx4 v18, s[20:23], s48 offen offset:3072 sc1 lds
    s_mov_b32 exec_hi, -1
    s_add_u32 s48, s48, 14336
    s_add_u32 s51, s51, 14336
    s_cmp_eq_u32 s51, 153600
    s_cselect_b32 s51, 81920, s51
    s_add_u32 m0, s49, s50
    s_nop 0
    buffer_load_dwordx4 v17, s[20:23], s47 offen offset:0 sc1 lds
    buffer_load_dwordx4 v17, s[20:23], s47 offen offset:1024 sc1 lds
    buffer_load_dwordx4 v17, s[20:23], s47 offen offset:2048 sc1 lds
    buffer_load_dwordx4 v17, s[20:23], s47 offen offset:3072 sc1 lds
    s_add_u32 s47, s47, 16384
    s_add_u32 s49, s49, 16384
    s_cmp_eq_u32 s49, 81920
    s_cselect_b32 s49, 0, s49
    s_waitcnt vmcnt(16)
    s_barrier
    s_add_u32 m0, s51, s52
    s_nop 0
    buffer_load_dwordx4 v18, s[20:23], s48 offen offset:0 sc1 lds
    buffer_load_dwordx4 v18, s[20:23], s48 offen offset:1024 sc1 lds
    buffer_load_dwordx4 v18, s[20:23], s48 offen offset:2048 sc1 lds
    s_mov_b32 exec_hi, 0
    buffer_load_dwordx4 v18, s[20:23], s48 offen offset:3072 sc1 lds
    s_mov_b32 exec_hi, -1
    s_add_u32 s48, s48, 14336
    s_add_u32 s51, s51, 14336
    s_cmp_eq_u32 s51, 153600
    s_cselect_b32 s51, 81920, s51
    s_add_u32 m0, s49, s50
    s_nop 0
    buffer_load_dwordx4 v17, s[20:23], s47 offen offset:0 sc1 lds
    buffer_load_dwordx4 v17, s[20:23], s47 offen offset:1024 sc1 lds
    buffer_load_dwordx4 v17, s[20:23], s47 offen offset:2048 sc1 lds
    buffer_load_dwordx4 v17, s[20:23], s47 offen offset:3072 sc1 lds
    s_add_u32 s47, s47, 16384
    s_add_u32 s49, s49, 16384
    s_cmp_eq_u32 s49, 81920
    s_cselect_b32 s49, 0, s49
    s_waitcnt vmcnt(16)
    s_barrier
    s_add_u32 m0, s51, s52
    s_nop 0
    buffer_load_dwordx4 v18, s[20:23], s48 offen offset:0 sc1 lds
    buffer_load_dwordx4 v18, s[20:23], s48 offen offset:1024 sc1 lds
    buffer_load_dwordx4 v18, s[20:23], s48 offen offset:2048 sc1 lds
    s_mov_b32 exec_hi, 0
    buffer_load_dwordx4 v18, s[20:23], s48 offen offset:3072 sc1 lds
    s_mov_b32 exec_hi, -1
    s_add_u32 s48, s48, 14336
    s_add_u32 s51, s51, 14336
    s_cmp_eq_u32 s51, 153600
    s_cselect_b32 s51, 81920, s51
    s_waitcnt vmcnt(12)
    s_barrier
    s_add_u32 m0, s49, s50
    s_nop 0
    buffer_load_dwordx4 v17, s[20:23], s47 offen offset:0 sc1 lds
    buffer_load_dwordx4 v17, s[20:23], s47 offen offset:1024 sc1 lds
    buffer_load_dwordx4 v17, s[20:23], s47 offen offset:2048 sc1 lds
    buffer_load_dwordx4 v17, s[20:23], s47 offen offset:3072 sc1 lds
    s_add_u32 s47, s47, 16384
    s_add_u32 s49, s49, 16384
    s_cmp_eq_u32 s49, 81920
    s_cselect_b32 s49, 0, s49
    s_add_u32 m0, s51, s52
    s_nop 0
    buffer_load_dwordx4 v18, s[20:23], s48 offen offset:0 sc1 lds
    buffer_load_dwordx4 v18, s[20:23], s48 offen offset:1024 sc1 lds
    buffer_load_dwordx4 v18, s[20:23], s48 offen offset:2048 sc1 lds
    s_mov_b32 exec_hi, 0
    buffer_load_dwordx4 v18, s[20:23], s48 offen offset:3072 sc1 lds
    s_mov_b32 exec_hi, -1
    s_add_u32 s48, s48, 14336
    s_add_u32 s51, s51, 14336
    s_cmp_eq_u32 s51, 153600
    s_cselect_b32 s51, 81920, s51
    s_waitcnt vmcnt(12)
    s_barrier
    s_add_u32 m0, s49, s50
    s_nop 0
    buffer_load_dwordx4 v17, s[20:23], s47 offen offset:0 sc1 lds
    buffer_load_dwordx4 v17, s[20:23], s47 offen offset:1024 sc1 lds
    buffer_load_dwordx4 v17, s[20:23], s47 offen offset:2048 sc1 lds
    buffer_load_dwordx4 v17, s[20:23], s47 offen offset:3072 sc1 lds
    s_add_u32 s47, s47, 16384
    s_add_u32 s49, s49, 16384
    s_cmp_eq_u32 s49, 81920
    s_cselect_b32 s49, 0, s49
    s_add_u32 m0, s51, s52
    s_nop 0
    buffer_load_dwordx4 v18, s[20:23], s48 offen offset:0 sc1 lds
    buffer_load_dwordx4 v18, s[20:23], s48 offen offset:1024 sc1 lds
    buffer_load_dwordx4 v18, s[20:23], s48 offen offset:2048 sc1 lds
    s_mov_b32 exec_hi, 0
    buffer_load_dwordx4 v18, s[20:23], s48 offen offset:3072 sc1 lds
    s_mov_b32 exec_hi, -1
    s_add_u32 s48, s48, 14336
    s_add_u32 s51, s51, 14336
    s_cmp_eq_u32 s51, 153600
    s_cselect_b32 s51, 81920, s51
    s_waitcnt vmcnt(12)
    s_barrier
    s_add_u32 m0, s49, s50
    s_nop 0
    buffer_load_dwordx4 v17, s[20:23], s47 offen offset:0 sc1 lds
    buffer_load_dwordx4 v17, s[20:23], s47 offen offset:1024 sc1 lds
    buffer_load_dwordx4 v17, s[20:23], s47 offen offset:2048 sc1 lds
    buffer_load_dwordx4 v17, s[20:23], s47 offen offset:3072 sc1 lds
    s_add_u32 s47, s47, 16384
    s_add_u32 s49, s49, 16384
    s_cmp_eq_u32 s49, 81920
    s_cselect_b32 s49, 0, s49
    s_mov_b32 s15, 16
L_ll_36:
    s_waitcnt vmcnt(8)
    s_barrier
    s_add_u32 m0, s51, s52
    s_nop 0
    buffer_load_dwordx4 v18, s[20:23], s48 offen offset:0 sc1 lds
    buffer_load_dwordx4 v18, s[20:23], s48 offen offset:1024 sc1 lds
    buffer_load_dwordx4 v18, s[20:23], s48 offen offset:2048 sc1 lds
    s_mov_b32 exec_hi, 0
    buffer_load_dwordx4 v18, s[20:23], s48 offen offset:3072 sc1 lds
    s_mov_b32 exec_hi, -1
    s_add_u32 s48, s48, 14336
    s_add_u32 s51, s51, 14336
    s_cmp_eq_u32 s51, 153600
    s_cselect_b32 s51, 81920, s51
    s_add_u32 m0, s49, s50
    s_nop 0
    buffer_load_dwordx4 v17, s[20:23], s47 offen offset:0 sc1 lds
    buffer_load_dwordx4 v17, s[20:23], s47 offen offset:1024 sc1 lds
    buffer_load_dwordx4 v17, s[20:23], s47 offen offset:2048 sc1 lds
    buffer_load_dwordx4 v17, s[20:23], s47 offen offset:3072 sc1 lds
    s_add_u32 s47, s47, 16384
    s_add_u32 s49, s49, 16384
    s_cmp_eq_u32 s49, 81920
    s_cselect_b32 s49, 0, s49
    s_sub_u32 s15, s15, 1
    s_cmp_lg_u32 s15, 0
    s_nop 7
    s_cbranch_scc1 L_ll_36
    s_mul_i32 s54, s43, 458752
    s_add_u32 s54, s54, 30408704
    s_mul_i32 s55, s44, 229376
    s_add_u32 s55, s55, 75497472
    s_mov_b32 s56, 0
    s_mul_i32 s57, s16, 4096
    v_add_u32 v55, s57, v2
    s_mov_b32 s58, 81920
    s_mul_i32 s59, s16, 2048
    v_add_u32 v56, s59, v2
    s_waitcnt vmcnt(8)
    s_barrier
    s_add_u32 m0, s51, s52
    s_nop 0
    buffer_load_dwordx4 v18, s[20:23], s48 offen offset:0 sc1 lds
    buffer_load_dwordx4 v18, s[20:23], s48 offen offset:1024 sc1 lds
    buffer_load_dwordx4 v18, s[20:23], s48 offen offset:2048 sc1 lds
    s_mov_b32 exec_hi, 0
    buffer_load_dwordx4 v18, s[20:23], s48 offen offset:3072 sc1 lds
    s_mov_b32 exec_hi, -1
    s_add_u32 s48, s48, 14336
    s_add_u32 s51, s51, 14336
    s_cmp_eq_u32 s51, 153600
    s_cselect_b32 s51, 81920, s51
    s_add_u32 m0, s49, s50
    s_nop 0
    buffer_load_dwordx4 v17, s[20:23], s47 offen offset:0 sc1 lds
    buffer_load_dwordx4 v17, s[20:23], s47 offen offset:1024 sc1 lds
    buffer_load_dwordx4 v17, s[20:23], s47 offen offset:2048 sc1 lds
    buffer_load_dwordx4 v17, s[20:23], s47 offen offset:3072 sc1 lds
    s_add_u32 s47, s47, 16384
    s_add_u32 s49, s49, 16384
    s_cmp_eq_u32 s49, 81920
    s_cselect_b32 s49, 0, s49
    s_waitcnt vmcnt(8)
    s_barrier
    s_waitcnt vmcnt(0)
    s_barrier
    s_mov_b32 s15, 4
L_ll_37:
    s_add_u32 m0, s58, s59
    s_nop 0
    buffer_load_dwordx4 v56, s[20:23], s55 offen offset:0 sc1 lds
    buffer_load_dwordx4 v56, s[20:23], s55 offen offset:1024 sc1 lds
    s_add_u32 s55, s55, 8192
    s_add_u32 s58, s58, 8192
    s_cmp_eq_u32 s58, 163840
    s_cselect_b32 s58, 81920, s58
    s_sub_u32 s15, s15, 1
    s_cmp_lg_u32 s15, 0
    s_nop 7
    s_cbranch_scc1 L_ll_37
    s_barrier
    s_mov_b32 s15, 3
L_ll_38:
    s_add_u32 m0, s58, s59
    s_nop 0
    buffer_load_dwordx4 v56, s[20:23], s55 offen offset:0 sc1 lds
    buffer_load_dwordx4 v56, s[20:23], s55 offen offset:1024 sc1 lds
    s_add_u32 s55, s55, 8192
    s_add_u32 s58, s58, 8192
    s_cmp_eq_u32 s58, 163840
    s_cselect_b32 s58, 81920, s58
    s_sub_u32 s15, s15, 1
    s_cmp_lg_u32 s15, 0
    s_nop 7
    s_cbranch_scc1 L_ll_38
    s_barrier
    s_mov_b32 s15, 3
L_ll_39:
    s_add_u32 m0, s58, s59
    s_nop 0
    buffer_load_dwordx4 v56, s[20:23], s55 offen offset:0 sc1 lds
    buffer_load_dwordx4 v56, s[20:23], s55 offen offset:1024 sc1 lds
    s_add_u32 s55, s55, 8192
    s_add_u32 s58, s58, 8192
    s_cmp_eq_u32 s58, 163840
    s_cselect_b32 s58, 81920, s58
    s_sub_u32 s15, s15, 1
    s_cmp_lg_u32 s15, 0
    s_nop 7
    s_cbranch_scc1 L_ll_39
    s_barrier
    s_add_u32 m0, s56, s57
    s_nop 0
    buffer_load_dwordx4 v55, s[20:23], s54 offen offset:0 sc1 lds
    buffer_load_dwordx4 v55, s[20:23], s54 offen offset:1024 sc1 lds
    buffer_load_dwordx4 v55, s[20:23], s54 offen offset:2048 sc1 lds
    buffer_load_dwordx4 v55, s[20:23], s54 offen offset:3072 sc1 lds
    s_add_u32 s54, s54, 16384
    s_add_u32 s56, s56, 16384
    s_cmp_eq_u32 s56, 65536
    s_cselect_b32 s56, 0, s56
    s_add_u32 m0, s56, s57
    s_nop 0
    buffer_load_dwordx4 v55, s[20:23], s54 offen offset:0 sc1 lds
    buffer_load_dwordx4 v55, s[20:23], s54 offen offset:1024 sc1 lds
    buffer_load_dwordx4 v55, s[20:23], s54 offen offset:2048 sc1 lds
    buffer_load_dwordx4 v55, s[20:23], s54 offen offset:3072 sc1 lds
    s_add_u32 s54, s54, 16384
    s_add_u32 s56, s56, 16384
    s_cmp_eq_u32 s56, 65536
    s_cselect_b32 s56, 0, s56
    s_add_u32 m0, s56, s57
    s_nop 0
    buffer_load_dwordx4 v55, s[20:23], s54 offen offset:0 sc1 lds
    buffer_load_dwordx4 v55, s[20:23], s54 offen offset:1024 sc1 lds
    buffer_load_dwordx4 v55, s[20:23], s54 offen offset:2048 sc1 lds
    buffer_load_dwordx4 v55, s[20:23], s54 offen offset:3072 sc1 lds
    s_add_u32 s54, s54, 16384
    s_add_u32 s56, s56, 16384
    s_cmp_eq_u32 s56, 65536
    s_cselect_b32 s56, 0, s56
    s_waitcnt vmcnt(8)
    s_barrier
    s_add_u32 m0, s56, s57
    s_nop 0
    buffer_load_dwordx4 v55, s[20:23], s54 offen offset:0 sc1 lds
    buffer_load_dwordx4 v55, s[20:23], s54 offen offset:1024 sc1 lds
    buffer_load_dwordx4 v55, s[20:23], s54 offen offset:2048 sc1 lds
    buffer_load_dwordx4 v55, s[20:23], s54 offen offset:3072 sc1 lds
    s_add_u32 s54, s54, 16384
    s_add_u32 s56, s56, 16384
    s_cmp_eq_u32 s56, 65536
    s_cselect_b32 s56, 0, s56
    s_waitcnt vmcnt(8)
    s_barrier
    s_add_u32 m0, s56, s57
    s_nop 0
    buffer_load_dwordx4 v55, s[20:23], s54 offen offset:0 sc1 lds
    buffer_load_dwordx4 v55, s[20:23], s54 offen offset:1024 sc1 lds
    buffer_load_dwordx4 v55, s[20:23], s54 offen offset:2048 sc1 lds
    buffer_load_dwordx4 v55, s[20:23], s54 offen offset:3072 sc1 lds
    s_add_u32 s54, s54, 16384
    s_add_u32 s56, s56, 16384
    s_cmp_eq_u32 s56, 65536
    s_cselect_b32 s56, 0, s56
    s_add_u32 m0, s58, s59
    s_nop 0
    buffer_load_dwordx4 v56, s[20:23], s55 offen offset:0 sc1 lds
    buffer_load_dwordx4 v56, s[20:23], s55 offen offset:1024 sc1 lds
    s_add_u32 s55, s55, 8192
    s_add_u32 s58, s58, 8192
    s_cmp_eq_u32 s58, 163840
    s_cselect_b32 s58, 81920, s58
    s_waitcnt vmcnt(10)
    s_barrier
    s_add_u32 m0, s56, s57
    s_nop 0
    buffer_load_dwordx4 v55, s[20:23], s54 offen offset:0 sc1 lds
    buffer_load_dwordx4 v55, s[20:23], s54 offen offset:1024 sc1 lds
    buffer_load_dwordx4 v55, s[20:23], s54 offen offset:2048 sc1 lds
    buffer_load_dwordx4 v55, s[20:23], s54 offen offset:3072 sc1 lds
    s_add_u32 s54, s54, 16384
    s_add_u32 s56, s56, 16384
    s_cmp_eq_u32 s56, 65536
    s_cselect_b32 s56, 0, s56
    s_add_u32 m0, s58, s59
    s_nop 0
    buffer_load_dwordx4 v56, s[20:23], s55 offen offset:0 sc1 lds
    buffer_load_dwordx4 v56, s[20:23], s55 offen offset:1024 sc1 lds
    s_add_u32 s55, s55, 8192
    s_add_u32 s58, s58, 8192
    s_cmp_eq_u32 s58, 163840
    s_cselect_b32 s58, 81920, s58
    s_waitcnt vmcnt(12)
    s_barrier
    s_add_u32 m0, s56, s57
    s_nop 0
    buffer_load_dwordx4 v55, s[20:23], s54 offen offset:0 sc1 lds
    buffer_load_dwordx4 v55, s[20:23], s54 offen offset:1024 sc1 lds
    buffer_load_dwordx4 v55, s[20:23], s54 offen offset:2048 sc1 lds
    buffer_load_dwordx4 v55, s[20:23], s54 offen offset:3072 sc1 lds
    s_add_u32 s54, s54, 16384
    s_add_u32 s56, s56, 16384
    s_cmp_eq_u32 s56, 65536
    s_cselect_b32 s56, 0, s56
    s_add_u32 m0, s58, s59
    s_nop 0
    buffer_load_dwordx4 v56, s[20:23], s55 offen offset:0 sc1 lds
    buffer_load_dwordx4 v56, s[20:23], s55 offen offset:1024 sc1 lds
    s_add_u32 s55, s55, 8192
    s_add_u32 s58, s58, 8192
    s_cmp_eq_u32 s58, 163840
    s_cselect_b32 s58, 81920, s58
    s_mov_b32 s15, 15
L_ll_40:
    s_waitcnt vmcnt(14)
    s_barrier
    s_add_u32 m0, s56, s57
    s_nop 0
    buffer_load_dwordx4 v55, s[20:23], s54 offen offset:0 sc1 lds
    buffer_load_dwordx4 v55, s[20:23], s54 offen offset:1024 sc1 lds
    buffer_load_dwordx4 v55, s[20:23], s54 offen offset:2048 sc1 lds
    buffer_load_dwordx4 v55, s[20:23], s54 offen offset:3072 sc1 lds
    s_add_u32 s54, s54, 16384
    s_add_u32 s56, s56, 16384
    s_cmp_eq_u32 s56, 65536
    s_cselect_b32 s56, 0, s56
    s_add_u32 m0, s58, s59
    s_nop 0
    buffer_load_dwordx4 v56, s[20:23], s55 offen offset:0 sc1 lds
    buffer_load_dwordx4 v56, s[20:23], s55 offen offset:1024 sc1 lds
    s_add_u32 s55, s55, 8192
    s_add_u32 s58, s58, 8192
    s_cmp_eq_u32 s58, 163840
    s_cselect_b32 s58, 81920, s58
    s_sub_u32 s15, s15, 1
    s_cmp_lg_u32 s15, 0
    s_nop 7
    s_cbranch_scc1 L_ll_40
    s_waitcnt vmcnt(14)
    s_barrier
    s_add_u32 m0, s56, s57
    s_nop 0
    buffer_load_dwordx4 v55, s[20:23], s54 offen offset:0 sc1 lds
    buffer_load_dwordx4 v55, s[20:23], s54 offen offset:1024 sc1 lds
    buffer_load_dwordx4 v55, s[20:23], s54 offen offset:2048 sc1 lds
    buffer_load_dwordx4 v55, s[20:23], s54 offen offset:3072 sc1 lds
    s_add_u32 s54, s54, 16384
    s_add_u32 s56, s56, 16384
    s_cmp_eq_u32 s56, 65536
    s_cselect_b32 s56, 0, s56
    s_waitcnt vmcnt(12)
    s_barrier
    s_add_u32 m0, s56, s57
    s_nop 0
    buffer_load_dwordx4 v55, s[20:23], s54 offen offset:0 sc1 lds
    buffer_load_dwordx4 v55, s[20:23], s54 offen offset:1024 sc1 lds
    buffer_load_dwordx4 v55, s[20:23], s54 offen offset:2048 sc1 lds
    buffer_load_dwordx4 v55, s[20:23], s54 offen offset:3072 sc1 lds
    s_add_u32 s54, s54, 16384
    s_add_u32 s56, s56, 16384
    s_cmp_eq_u32 s56, 65536
    s_cselect_b32 s56, 0, s56
    s_waitcnt vmcnt(10)
    s_barrier
    s_add_u32 m0, s56, s57
    s_nop 0
    buffer_load_dwordx4 v55, s[20:23], s54 offen offset:0 sc1 lds
    buffer_load_dwordx4 v55, s[20:23], s54 offen offset:1024 sc1 lds
    buffer_load_dwordx4 v55, s[20:23], s54 offen offset:2048 sc1 lds
    buffer_load_dwordx4 v55, s[20:23], s54 offen offset:3072 sc1 lds
    s_add_u32 s54, s54, 16384
    s_add_u32 s56, s56, 16384
    s_cmp_eq_u32 s56, 65536
    s_cselect_b32 s56, 0, s56
    s_mov_b32 s15, 3
L_ll_41:
    s_waitcnt vmcnt(8)
    s_barrier
    s_add_u32 m0, s56, s57
    s_nop 0
    buffer_load_dwordx4 v55, s[20:23], s54 offen offset:0 sc1 lds
    buffer_load_dwordx4 v55, s[20:23], s54 offen offset:1024 sc1 lds
    buffer_load_dwordx4 v55, s[20:23], s54 offen offset:2048 sc1 lds
    buffer_load_dwordx4 v55, s[20:23], s54 offen offset:3072 sc1 lds
    s_add_u32 s54, s54, 16384
    s_add_u32 s56, s56, 16384
    s_cmp_eq_u32 s56, 65536
    s_cselect_b32 s56, 0, s56
    s_sub_u32 s15, s15, 1
    s_cmp_lg_u32 s15, 0
    s_nop 7
    s_cbranch_scc1 L_ll_41
    s_waitcnt vmcnt(8)
    s_barrier
    s_waitcnt vmcnt(4)
    s_barrier
    s_waitcnt vmcnt(0)
    s_barrier
    s_endpgm
L_comp_23:
    s_lshr_b32 s28, s14, 1
    s_and_b32 s29, s14, 1
    s_lshl_b32 s30, s29, 1
    s_and_b32 s36, s2, 7
    s_lshr_b32 s34, s36, 1
    s_lshl_b32 s34, s34, 2
    s_and_b32 s35, s36, 1
    s_lshl_b32 s35, s35, 3
    s_lshr_b32 s37, s2, 6
    s_add_u32 s34, s34, s37
    s_lshr_b32 s36, s2, 3
    s_and_b32 s36, s36, 7
    s_add_u32 s35, s35, s36
    s_mov_b32 s38, 0
    s_lshl_b32 s3, s28, 12
    v_add_u32 v6, s3, v2
    s_mov_b32 s38, 131072
    s_mov_b32 s39, 49152
    v_lshrrev_b32 v5, 2, v1
    v_lshlrev_b32 v4, 7, v5
    v_and_b32 v5, 3, v1
    v_lshl_add_u32 v4, v5, 3, v4
    v_bfe_u32 v5, v1, 3, 2
    v_xor_b32 v5, s30, v5
    v_lshl_add_u32 v8, v5, 5, v4
    v_xor_b32 v10, 32, v8
    s_lshl_b32 s3, s28, 6
    s_lshl_b32 s3, s3, 7
    s_add_u32 s3, s3, 32768
    v_and_b32 v3, 15, v1
    v_lshlrev_b32 v92, 7, v3
    v_lshrrev_b32 v3, 1, v3
    v_lshrrev_b32 v4, 5, v1
    v_xor_b32 v3, v3, v4
    v_lshl_add_u32 v92, v3, 4, v92
    v_bfe_u32 v3, v1, 4, 1
    v_lshl_add_u32 v92, v3, 3, v92
    v_add_u32 v92, s3, v92
    s_lshl_b32 s3, s29, 6
    v_xor_b32 v92, s3, v92
    v_xor_b32 v93, 32, v92
    v_and_b32 v3, 15, v1
    v_lshlrev_b32 v94, 6, v3
    v_lshrrev_b32 v3, 4, v1
    v_lshl_add_u32 v94, v3, 3, v94
    s_lshl_b32 s3, s28, 12
    s_lshl_b32 s31, s29, 5
    s_add_u32 s3, s3, s31
    s_add_u32 s3, s3, 49152
    v_add_u32 v94, s3, v94
    s_lshl_b32 s31, s24, 18
    s_lshl_b32 s3, s25, 14
    s_add_u32 s31, s31, s3
    s_lshl_b32 s3, s29, 13
    s_add_u32 s31, s31, s3
    s_lshl_b32 s3, s28, 12
    s_add_u32 s31, s31, s3
    s_add_u32 s31, s31, 9437184
    s_waitcnt lgkmcnt(0)
    s_add_u32 s20, s8, 0
    s_addc_u32 s21, s9, 0
    v_add_u32 v7, s38, v6
    s_add_u32 s38, s38, 16384
    s_cmp_eq_u32 s38, 32768
    s_cselect_b32 s38, 131072, s38
    s_cmp_eq_u32 s38, 163840
    s_cselect_b32 s38, 0, s38
    v_add_u32 v9, s39, v8
    v_add_u32 v11, s39, v10
    s_add_u32 s39, s39, 8192
    s_cmp_eq_u32 s39, 131072
    s_cselect_b32 s39, 49152, s39
    s_and_b32 s42, s2, 7
    s_lshr_b32 s40, s42, 1
    s_lshl_b32 s40, s40, 2
    s_and_b32 s41, s42, 1
    s_lshl_b32 s41, s41, 3
    s_lshr_b32 s43, s2, 6
    s_add_u32 s40, s40, s43
    s_lshr_b32 s42, s2, 3
    s_and_b32 s42, s42, 7
    s_add_u32 s41, s41, s42
    s_lshl_b32 s3, s41, 2
    s_lshl_b32 s33, s40, 9
    s_add_u32 s33, s33, s3
    s_add_u32 s33, s33, 46235648
    s_lshl_b32 s3, s24, 9
    s_add_u32 s32, s3, 46235648
    v_lshlrev_b32 v3, 2, v1
    v_mov_b32 v4, 0
    s_cmp_lg_u32 s14, 0
    s_waitcnt vmcnt(0)
    s_barrier
    s_cbranch_scc1 L_rdy_42
    s_mov_b64 exec, 1
    v_mov_b32 v52, 1
    buffer_atomic_add v52, v4, s[20:23], s32 offen offset:256 sc0 sc1
    buffer_store_dword v4, v4, s[20:23], s33 offen sc1
    s_waitcnt vmcnt(1)
    v_cmp_eq_u32 vcc, 14, v52
    s_cbranch_vccnz L_wt_43x
L_wt_43:
    s_sleep 1
    v_mov_b32 v52, 0
    buffer_atomic_add v52, v4, s[20:23], s32 offen offset:256 sc0 sc1
    s_waitcnt vmcnt(0)
    v_cmp_ne_u32 vcc, 15, v52
    s_cbranch_vccnz L_wt_43
L_wt_43x:
    s_mov_b64 exec, -1
L_rdy_42:
    s_barrier
    ds_read_b64 v[76:77], v92 offset:0
    ds_read_b64 v[78:79], v93 offset:0
    ds_read_b64 v[80:81], v92 offset:2048
    ds_read_b64 v[82:83], v93 offset:2048
    ds_read_b64 v[84:85], v92 offset:4096
    ds_read_b64 v[86:87], v93 offset:4096
    ds_read_b64 v[88:89], v92 offset:6144
    ds_read_b64 v[90:91], v93 offset:6144
    s_waitcnt lgkmcnt(0)
    v_lshlrev_b32 v12, 16, v76
    v_and_b32 v13, 0xffff0000, v76
    v_lshlrev_b32 v14, 16, v77
    v_and_b32 v15, 0xffff0000, v77
    v_lshlrev_b32 v28, 16, v78
    v_and_b32 v29, 0xffff0000, v78
    v_lshlrev_b32 v30, 16, v79
    v_and_b32 v31, 0xffff0000, v79
    v_lshlrev_b32 v16, 16, v80
    v_and_b32 v17, 0xffff0000, v80
    v_lshlrev_b32 v18, 16, v81
    v_and_b32 v19, 0xffff0000, v81
    v_lshlrev_b32 v32, 16, v82
    v_and_b32 v33, 0xffff0000, v82
    v_lshlrev_b32 v34, 16, v83
    v_and_b32 v35, 0xffff0000, v83
    v_lshlrev_b32 v20, 16, v84
    v_and_b32 v21, 0xffff0000, v84
    v_lshlrev_b32 v22, 16, v85
    v_and_b32 v23, 0xffff0000, v85
    v_lshlrev_b32 v36, 16, v86
    v_and_b32 v37, 0xffff0000, v86
    v_lshlrev_b32 v38, 16, v87
    v_and_b32 v39, 0xffff0000, v87
    v_lshlrev_b32 v24, 16, v88
    v_and_b32 v25, 0xffff0000, v88
    v_lshlrev_b32 v26, 16, v89
    v_and_b32 v27, 0xffff0000, v89
    v_lshlrev_b32 v40, 16, v90
    v_and_b32 v41, 0xffff0000, v90
    v_lshlrev_b32 v42, 16, v91
    v_and_b32 v43, 0xffff0000, v91
    s_lshl_b32 s3, s25, 2
    s_lshl_b32 s33, s24, 9
    s_add_u32 s33, s33, s3
    s_add_u32 s33, s33, 46137344
    s_barrier
    ds_read_b128 v[60:63], v7 offset:0
    ds_read_b128 v[64:67], v7 offset:1024
    ds_read_b128 v[68:71], v7 offset:2048
    ds_read_b128 v[72:75], v7 offset:3072
    ds_read_b64_tr_b16 v[44:45], v9 offset:0
    ds_read_b64_tr_b16 v[46:47], v9 offset:2048
    ds_read_b64_tr_b16 v[48:49], v11 offset:0
    ds_read_b64_tr_b16 v[50:51], v11 offset:2048
    s_mov_b32 s15, 15
L_loop_44:
    s_waitcnt lgkmcnt(0)
    v_mfma_f32_16x16x32_bf16 v[12:15], v[44:47], v[60:63], v[12:15]
    ds_read_b128 v[76:79], v7 offset:8192
    ds_read_b128 v[80:83], v7 offset:9216
    ds_read_b128 v[84:87], v7 offset:10240
    ds_read_b128 v[88:91], v7 offset:11264
    v_mfma_f32_16x16x32_bf16 v[16:19], v[44:47], v[64:67], v[16:19]
    ds_read_b64_tr_b16 v[52:53], v9 offset:4096
    ds_read_b64_tr_b16 v[54:55], v9 offset:6144
    ds_read_b64_tr_b16 v[56:57], v11 offset:4096
    v_mfma_f32_16x16x32_bf16 v[20:23], v[44:47], v[68:71], v[20:23]
    ds_read_b64_tr_b16 v[58:59], v11 offset:6144
    v_add_u32 v7, s38, v6
    s_add_u32 s38, s38, 16384
    v_mfma_f32_16x16x32_bf16 v[24:27], v[44:47], v[72:75], v[24:27]
    s_cmp_eq_u32 s38, 32768
    s_cselect_b32 s38, 131072, s38
    s_cmp_eq_u32 s38, 163840
    v_mfma_f32_16x16x32_bf16 v[28:31], v[48:51], v[60:63], v[28:31]
    s_cselect_b32 s38, 0, s38
    v_add_u32 v9, s39, v8
    v_add_u32 v11, s39, v10
    v_mfma_f32_16x16x32_bf16 v[32:35], v[48:51], v[64:67], v[32:35]
    s_add_u32 s39, s39, 8192
    s_cmp_eq_u32 s39, 131072
    s_cselect_b32 s39, 49152, s39
    v_mfma_f32_16x16x32_bf16 v[36:39], v[48:51], v[68:71], v[36:39]
    v_mfma_f32_16x16x32_bf16 v[40:43], v[48:51], v[72:75], v[40:43]
    s_waitcnt lgkmcnt(0)
    s_barrier
    v_mfma_f32_16x16x32_bf16 v[12:15], v[52:55], v[76:79], v[12:15]
    ds_read_b128 v[60:63], v7 offset:0
    ds_read_b128 v[64:67], v7 offset:1024
    v_mfma_f32_16x16x32_bf16 v[16:19], v[52:55], v[80:83], v[16:19]
    ds_read_b128 v[68:71], v7 offset:2048
    ds_read_b128 v[72:75], v7 offset:3072
    v_mfma_f32_16x16x32_bf16 v[20:23], v[52:55], v[84:87], v[20:23]
    ds_read_b64_tr_b16 v[44:45], v9 offset:0
    v_mfma_f32_16x16x32_bf16 v[24:27], v[52:55], v[88:91], v[24:27]
    ds_read_b64_tr_b16 v[46:47], v9 offset:2048
    ds_read_b64_tr_b16 v[48:49], v11 offset:0
    v_mfma_f32_16x16x32_bf16 v[28:31], v[56:59], v[76:79], v[28:31]
    ds_read_b64_tr_b16 v[50:51], v11 offset:2048
    s_sub_u32 s15, s15, 1
    v_mfma_f32_16x16x32_bf16 v[32:35], v[56:59], v[80:83], v[32:35]
    s_cmp_lg_u32 s15, 0
    v_mfma_f32_16x16x32_bf16 v[36:39], v[56:59], v[84:87], v[36:39]
    v_mfma_f32_16x16x32_bf16 v[40:43], v[56:59], v[88:91], v[40:43]
    s_cbranch_scc1 L_loop_44
    s_waitcnt lgkmcnt(0)
    v_mfma_f32_16x16x32_bf16 v[12:15], v[44:47], v[60:63], v[12:15]
    ds_read_b128 v[76:79], v7 offset:8192
    ds_read_b128 v[80:83], v7 offset:9216
    v_mfma_f32_16x16x32_bf16 v[16:19], v[44:47], v[64:67], v[16:19]
    ds_read_b128 v[84:87], v7 offset:10240
    v_mfma_f32_16x16x32_bf16 v[20:23], v[44:47], v[68:71], v[20:23]
    ds_read_b128 v[88:91], v7 offset:11264
    v_mfma_f32_16x16x32_bf16 v[24:27], v[44:47], v[72:75], v[24:27]
    ds_read_b64_tr_b16 v[52:53], v9 offset:4096
    ds_read_b64_tr_b16 v[54:55], v9 offset:6144
    v_mfma_f32_16x16x32_bf16 v[28:31], v[48:51], v[60:63], v[28:31]
    ds_read_b64_tr_b16 v[56:57], v11 offset:4096
    v_mfma_f32_16x16x32_bf16 v[32:35], v[48:51], v[64:67], v[32:35]
    ds_read_b64_tr_b16 v[58:59], v11 offset:6144
    v_mfma_f32_16x16x32_bf16 v[36:39], v[48:51], v[68:71], v[36:39]
    v_mfma_f32_16x16x32_bf16 v[40:43], v[48:51], v[72:75], v[40:43]
    s_waitcnt lgkmcnt(0)
    s_barrier
    v_mfma_f32_16x16x32_bf16 v[12:15], v[52:55], v[76:79], v[12:15]
    v_mfma_f32_16x16x32_bf16 v[16:19], v[52:55], v[80:83], v[16:19]
    v_mfma_f32_16x16x32_bf16 v[20:23], v[52:55], v[84:87], v[20:23]
    v_mfma_f32_16x16x32_bf16 v[24:27], v[52:55], v[88:91], v[24:27]
    v_mfma_f32_16x16x32_bf16 v[28:31], v[56:59], v[76:79], v[28:31]
    v_mfma_f32_16x16x32_bf16 v[32:35], v[56:59], v[80:83], v[32:35]
    v_mfma_f32_16x16x32_bf16 v[36:39], v[56:59], v[84:87], v[36:39]
    v_mfma_f32_16x16x32_bf16 v[40:43], v[56:59], v[88:91], v[40:43]
    s_nop 0
    s_nop 1
    v_cvt_pk_bf16_f32 v76, v12, v13
    v_cvt_pk_bf16_f32 v77, v14, v15
    v_cvt_pk_bf16_f32 v78, v28, v29
    v_cvt_pk_bf16_f32 v79, v30, v31
    buffer_store_dwordx4 v[76:79], v2, s[20:23], s31 offen offset:0 sc1
    v_cvt_pk_bf16_f32 v80, v16, v17
    v_cvt_pk_bf16_f32 v81, v18, v19
    v_cvt_pk_bf16_f32 v82, v32, v33
    v_cvt_pk_bf16_f32 v83, v34, v35
    buffer_store_dwordx4 v[80:83], v2, s[20:23], s31 offen offset:1024 sc1
    v_cvt_pk_bf16_f32 v84, v20, v21
    v_cvt_pk_bf16_f32 v85, v22, v23
    v_cvt_pk_bf16_f32 v86, v36, v37
    v_cvt_pk_bf16_f32 v87, v38, v39
    buffer_store_dwordx4 v[84:87], v2, s[20:23], s31 offen offset:2048 sc1
    v_cvt_pk_bf16_f32 v88, v24, v25
    v_cvt_pk_bf16_f32 v89, v26, v27
    v_cvt_pk_bf16_f32 v90, v40, v41
    v_cvt_pk_bf16_f32 v91, v42, v43
    buffer_store_dwordx4 v[88:91], v2, s[20:23], s31 offen offset:3072 sc1
    v_pk_add_f32 v[52:53], v[12:13], v[14:15]
    v_pk_mul_f32 v[54:55], v[12:13], v[12:13]
    v_pk_add_f32 v[52:53], v[52:53], v[28:29]
    v_pk_fma_f32 v[54:55], v[14:15], v[14:15], v[54:55]
    v_pk_add_f32 v[52:53], v[52:53], v[30:31]
    v_pk_fma_f32 v[54:55], v[28:29], v[28:29], v[54:55]
    v_add_f32 v44, v52, v53
    v_pk_fma_f32 v[54:55], v[30:31], v[30:31], v[54:55]
    v_add_f32 v45, v54, v55
    ds_write_b64 v94, v[44:45] offset:0
    v_pk_add_f32 v[52:53], v[16:17], v[18:19]
    v_pk_mul_f32 v[54:55], v[16:17], v[16:17]
    v_pk_add_f32 v[52:53], v[52:53], v[32:33]
    v_pk_fma_f32 v[54:55], v[18:19], v[18:19], v[54:55]
    v_pk_add_f32 v[52:53], v[52:53], v[34:35]
    v_pk_fma_f32 v[54:55], v[32:33], v[32:33], v[54:55]
    v_add_f32 v46, v52, v53
    v_pk_fma_f32 v[54:55], v[34:35], v[34:35], v[54:55]
    v_add_f32 v47, v54, v55
    ds_write_b64 v94, v[46:47] offset:1024
    v_pk_add_f32 v[52:53], v[20:21], v[22:23]
    v_pk_mul_f32 v[54:55], v[20:21], v[20:21]
    v_pk_add_f32 v[52:53], v[52:53], v[36:37]
    v_pk_fma_f32 v[54:55], v[22:23], v[22:23], v[54:55]
    v_pk_add_f32 v[52:53], v[52:53], v[38:39]
    v_pk_fma_f32 v[54:55], v[36:37], v[36:37], v[54:55]
    v_add_f32 v48, v52, v53
    v_pk_fma_f32 v[54:55], v[38:39], v[38:39], v[54:55]
    v_add_f32 v49, v54, v55
    ds_write_b64 v94, v[48:49] offset:2048
    v_pk_add_f32 v[52:53], v[24:25], v[26:27]
    v_pk_mul_f32 v[54:55], v[24:25], v[24:25]
    v_pk_add_f32 v[52:53], v[52:53], v[40:41]
    v_pk_fma_f32 v[54:55], v[26:27], v[26:27], v[54:55]
    v_pk_add_f32 v[52:53], v[52:53], v[42:43]
    v_pk_fma_f32 v[54:55], v[40:41], v[40:41], v[54:55]
    v_add_f32 v50, v52, v53
    v_pk_fma_f32 v[54:55], v[42:43], v[42:43], v[54:55]
    v_add_f32 v51, v54, v55
    ds_write_b64 v94, v[50:51] offset:3072
    s_cmp_ge_u32 s14, 2
    v_lshlrev_b32 v3, 6, v0
    v_add_u32 v3, 49152, v3
    s_waitcnt lgkmcnt(0)
    s_barrier
    s_cbranch_scc1 L_nost_45
    ds_read_b128 v[60:63], v3 offset:0
    ds_read_b128 v[64:67], v3 offset:16
    ds_read_b128 v[68:71], v3 offset:32
    ds_read_b128 v[72:75], v3 offset:48
    s_lshl_b32 s31, s24, 14
    s_lshl_b32 s3, s25, 10
    s_add_u32 s31, s31, s3
    s_add_u32 s31, s31, 13631488
    v_lshlrev_b32 v3, 3, v0
    s_waitcnt lgkmcnt(0)
    v_pk_add_f32 v[60:61], v[60:61], v[68:69]
    v_pk_add_f32 v[62:63], v[62:63], v[70:71]
    v_pk_add_f32 v[64:65], v[64:65], v[72:73]
    v_pk_add_f32 v[66:67], v[66:67], v[74:75]
    v_pk_add_f32 v[60:61], v[60:61], v[64:65]
    v_pk_add_f32 v[62:63], v[62:63], v[66:67]
    v_pk_add_f32 v[60:61], v[60:61], v[62:63]
    v_mov_b32 v238, v60
    v_and_b32 v239, 0x7fffffff, v61
L_nost_45:
    s_mov_b32 s38, 81920
    s_mov_b32 s3, 0
    v_add_u32 v6, s3, v2
    s_mov_b32 s39, 0
    s_lshl_b32 s3, s14, 11
    v_add_u32 v8, s3, v2
    v_add_u32 v9, s39, v8
    s_add_u32 s39, s39, 16384
    s_cmp_eq_u32 s39, 81920
    s_cselect_b32 s39, 0, s39
    v_add_u32 v7, s38, v6
    s_add_u32 s38, s38, 14336
    s_cmp_eq_u32 s38, 153600
    s_cselect_b32 s38, 81920, s38
    s_lshl_b32 s3, s34, 9
    s_add_u32 s32, s3, 46137344
    v_lshlrev_b32 v3, 2, v1
    v_mov_b32 v4, 0
    s_cmp_lg_u32 s14, 3
    s_waitcnt vmcnt(0)
    s_barrier
    s_cbranch_scc0 L_rdy_46p
    s_cmp_ge_u32 s14, 2
    s_cbranch_scc1 L_rdy_46p
    v_lshlrev_b32 v5, 3, v0
    buffer_store_dwordx2 v[238:239], v5, s[20:23], s31 offen sc1
    s_cmp_eq_u32 s3, s3
L_rdy_46p:
    s_cbranch_scc1 L_rdy_46
    s_mov_b64 exec, 1
    v_mov_b32 v96, 1
    buffer_atomic_add v96, v4, s[20:23], s32 offen offset:256 sc0 sc1
    s_waitcnt vmcnt(0)
    v_cmp_eq_u32 vcc, 14, v96
    s_cbranch_vccnz L_wt_47x
L_wt_47:
    s_sleep 1
    v_mov_b32 v96, 0
    buffer_atomic_add v96, v4, s[20:23], s32 offen offset:256 sc0 sc1
    s_waitcnt vmcnt(0)
    v_cmp_ne_u32 vcc, 15, v96
    s_cbranch_vccnz L_wt_47
L_wt_47x:
    s_mov_b64 exec, -1
L_rdy_46:
    s_barrier
    v_mov_b32 v12, 0
    v_mov_b32 v13, 0
    v_mov_b32 v14, 0
    v_mov_b32 v15, 0
    v_mov_b32 v16, 0
    v_mov_b32 v17, 0
    v_mov_b32 v18, 0
    v_mov_b32 v19, 0
    v_mov_b32 v20, 0
    v_mov_b32 v21, 0
    v_mov_b32 v22, 0
    v_mov_b32 v23, 0
    v_mov_b32 v24, 0
    v_mov_b32 v25, 0
    v_mov_b32 v26, 0
    v_mov_b32 v27, 0
    v_mov_b32 v28, 0
    v_mov_b32 v29, 0
    v_mov_b32 v30, 0
    v_mov_b32 v31, 0
    v_mov_b32 v32, 0
    v_mov_b32 v33, 0
    v_mov_b32 v34, 0
    v_mov_b32 v35, 0
    v_mov_b32 v36, 0
    v_mov_b32 v37, 0
    v_mov_b32 v38, 0
    v_mov_b32 v39, 0
    v_mov_b32 v40, 0
    v_mov_b32 v41, 0
    v_mov_b32 v42, 0
    v_mov_b32 v43, 0
    v_mov_b32 v44, 0
    v_mov_b32 v45, 0
    v_mov_b32 v46, 0
    v_mov_b32 v47, 0
    v_mov_b32 v48, 0
    v_mov_b32 v49, 0
    v_mov_b32 v50, 0
    v_mov_b32 v51, 0
    v_mov_b32 v52, 0
    v_mov_b32 v53, 0
    v_mov_b32 v54, 0
    v_mov_b32 v55, 0
    v_mov_b32 v56, 0
    v_mov_b32 v57, 0
    v_mov_b32 v58, 0
    v_mov_b32 v59, 0
    v_mov_b32 v60, 0
    v_mov_b32 v61, 0
    v_mov_b32 v62, 0
    v_mov_b32 v63, 0
    v_mov_b32 v64, 0
    v_mov_b32 v65, 0
    v_mov_b32 v66, 0
    v_mov_b32 v67, 0
    v_mov_b32 v140, 0
    v_mov_b32 v141, 0
    v_mov_b32 v142, 0
    v_mov_b32 v143, 0
    v_mov_b32 v144, 0
    v_mov_b32 v145, 0
    v_mov_b32 v146, 0
    v_mov_b32 v147, 0
    v_mov_b32 v148, 0
    v_mov_b32 v149, 0
    v_mov_b32 v150, 0
    v_mov_b32 v151, 0
    v_mov_b32 v152, 0
    v_mov_b32 v153, 0
    v_mov_b32 v154, 0
    v_mov_b32 v155, 0
    v_mov_b32 v156, 0
    v_mov_b32 v157, 0
    v_mov_b32 v158, 0
    v_mov_b32 v159, 0
    v_mov_b32 v160, 0
    v_mov_b32 v161, 0
    v_mov_b32 v162, 0
    v_mov_b32 v163, 0
    v_mov_b32 v164, 0
    v_mov_b32 v165, 0
    v_mov_b32 v166, 0
    v_mov_b32 v167, 0
    v_mov_b32 v168, 0
    v_mov_b32 v169, 0
    v_mov_b32 v170, 0
    v_mov_b32 v171, 0
    v_mov_b32 v172, 0
    v_mov_b32 v173, 0
    v_mov_b32 v174, 0
    v_mov_b32 v175, 0
    v_mov_b32 v176, 0
    v_mov_b32 v177, 0
    v_mov_b32 v178, 0
    v_mov_b32 v179, 0
    v_mov_b32 v180, 0
    v_mov_b32 v181, 0
    v_mov_b32 v182, 0
    v_mov_b32 v183, 0
    v_mov_b32 v184, 0
    v_mov_b32 v185, 0
    v_mov_b32 v186, 0
    v_mov_b32 v187, 0
    v_mov_b32 v188, 0
    v_mov_b32 v189, 0
    v_mov_b32 v190, 0
    v_mov_b32 v191, 0
    v_mov_b32 v192, 0
    v_mov_b32 v193, 0
    v_mov_b32 v194, 0
    v_mov_b32 v195, 0
    v_lshrrev_b32 v238, 4, v1
    v_lshlrev_b32 v238, 4, v238
    v_and_b32 v239, 15, v1
    v_lshlrev_b32 v239, 2, v239
    s_mov_b64 s[40:41], s[10:11]
    s_mov_b32 s42, 4096
    s_mov_b32 s43, 0x20000
    s_lshl_b32 s3, s34, 2
    s_add_u32 s3, s3, s14
    s_lshl_b32 s3, s3, 6
    v_lshrrev_b32 v3, 1, v239
    v_mov_b32 v236, 0
    v_mov_b32 v237, 0
    buffer_load_short_d16_hi v236, v3, s[40:43], s3 offen
    buffer_load_short_d16_hi v237, v3, s[40:43], s3 offen offset:32
    s_lshl_b32 s3, s34, 2
    s_lshl_b32 s33, s35, 9
    s_add_u32 s33, s33, s3
    s_add_u32 s33, s33, 46170112
    s_barrier
    ds_read_b128 v[124:127], v9 offset:0
    ds_read_b128 v[128:131], v9 offset:1024
    ds_read_b128 v[68:71], v7 offset:0
    ds_read_b128 v[72:75], v7 offset:1024
    ds_read_b128 v[76:79], v7 offset:2048
    ds_read_b128 v[80:83], v7 offset:3072
    ds_read_b128 v[84:87], v7 offset:4096
    ds_read_b128 v[88:91], v7 offset:5120
    ds_read_b128 v[92:95], v7 offset:6144
    s_mov_b32 s15, 15
L_loop_48:
    s_waitcnt lgkmcnt(0)
    v_mfma_f32_16x16x32_bf16 v[12:15], v[124:127], v[68:71], v[12:15]
    ds_read_b128 v[132:135], v9 offset:8192
    ds_read_b128 v[136:139], v9 offset:9216
    v_mfma_f32_16x16x32_bf16 v[16:19], v[128:131], v[68:71], v[16:19]
    ds_read_b128 v[96:99], v7 offset:7168
    ds_read_b128 v[100:103], v7 offset:8192
    v_mfma_f32_16x16x32_bf16 v[20:23], v[124:127], v[72:75], v[20:23]
    ds_read_b128 v[104:107], v7 offset:9216
    ds_read_b128 v[108:111], v7 offset:10240
    v_mfma_f32_16x16x32_bf16 v[24:27], v[128:131], v[72:75], v[24:27]
    ds_read_b128 v[112:115], v7 offset:11264
    v_mfma_f32_16x16x32_bf16 v[28:31], v[124:127], v[76:79], v[28:31]
    ds_read_b128 v[116:119], v7 offset:12288
    ds_read_b128 v[120:123], v7 offset:13312
    v_mfma_f32_16x16x32_bf16 v[32:35], v[128:131], v[76:79], v[32:35]
    v_add_u32 v9, s39, v8
    s_add_u32 s39, s39, 16384
    v_mfma_f32_16x16x32_bf16 v[36:39], v[124:127], v[80:83], v[36:39]
    s_cmp_eq_u32 s39, 81920
    v_mfma_f32_16x16x32_bf16 v[40:43], v[128:131], v[80:83], v[40:43]
    s_cselect_b32 s39, 0, s39
    v_add_u32 v7, s38, v6
    v_mfma_f32_16x16x32_bf16 v[44:47], v[124:127], v[84:87], v[44:47]
    s_add_u32 s38, s38, 14336
    s_cmp_eq_u32 s38, 153600
    v_mfma_f32_16x16x32_bf16 v[48:51], v[128:131], v[84:87], v[48:51]
    s_cselect_b32 s38, 81920, s38
    v_mfma_f32_16x16x32_bf16 v[52:55], v[124:127], v[88:91], v[52:55]
    v_mfma_f32_16x16x32_bf16 v[56:59], v[128:131], v[88:91], v[56:59]
    v_mfma_f32_16x16x32_bf16 v[60:63], v[124:127], v[92:95], v[60:63]
    v_mfma_f32_16x16x32_bf16 v[64:67], v[128:131], v[92:95], v[64:67]
    s_waitcnt lgkmcnt(0)
    s_barrier
    v_mfma_f32_16x16x32_bf16 v[12:15], v[132:135], v[96:99], v[12:15]
    ds_read_b128 v[124:127], v9 offset:0
    ds_read_b128 v[128:131], v9 offset:1024
    v_mfma_f32_16x16x32_bf16 v[16:19], v[136:139], v[96:99], v[16:19]
    ds_read_b128 v[68:71], v7 offset:0
    v_mfma_f32_16x16x32_bf16 v[20:23], v[132:135], v[100:103], v[20:23]
    ds_read_b128 v[72:75], v7 offset:1024
    v_mfma_f32_16x16x32_bf16 v[24:27], v[136:139], v[100:103], v[24:27]
    ds_read_b128 v[76:79], v7 offset:2048
    v_mfma_f32_16x16x32_bf16 v[28:31], v[132:135], v[104:107], v[28:31]
    ds_read_b128 v[80:83], v7 offset:3072
    v_mfma_f32_16x16x32_bf16 v[32:35], v[136:139], v[104:107], v[32:35]
    ds_read_b128 v[84:87], v7 offset:4096
    v_mfma_f32_16x16x32_bf16 v[36:39], v[132:135], v[108:111], v[36:39]
    ds_read_b128 v[88:91], v7 offset:5120
    v_mfma_f32_16x16x32_bf16 v[40:43], v[136:139], v[108:111], v[40:43]
    ds_read_b128 v[92:95], v7 offset:6144
    v_mfma_f32_16x16x32_bf16 v[44:47], v[132:135], v[112:115], v[44:47]
    s_sub_u32 s15, s15, 1
    v_mfma_f32_16x16x32_bf16 v[48:51], v[136:139], v[112:115], v[48:51]
    s_cmp_lg_u32 s15, 0
    v_mfma_f32_16x16x32_bf16 v[52:55], v[132:135], v[116:119], v[52:55]
    v_mfma_f32_16x16x32_bf16 v[56:59], v[136:139], v[116:119], v[56:59]
    v_mfma_f32_16x16x32_bf16 v[60:63], v[132:135], v[120:123], v[60:63]
    v_mfma_f32_16x16x32_bf16 v[64:67], v[136:139], v[120:123], v[64:67]
    s_cbranch_scc1 L_loop_48
    s_waitcnt lgkmcnt(0)
    v_mfma_f32_16x16x32_bf16 v[12:15], v[124:127], v[68:71], v[12:15]
    ds_read_b128 v[132:135], v9 offset:8192
    v_mfma_f32_16x16x32_bf16 v[16:19], v[128:131], v[68:71], v[16:19]
    ds_read_b128 v[136:139], v9 offset:9216
    v_mfma_f32_16x16x32_bf16 v[20:23], v[124:127], v[72:75], v[20:23]
    ds_read_b128 v[96:99], v7 offset:7168
    v_mfma_f32_16x16x32_bf16 v[24:27], v[128:131], v[72:75], v[24:27]
    ds_read_b128 v[100:103], v7 offset:8192
    v_mfma_f32_16x16x32_bf16 v[28:31], v[124:127], v[76:79], v[28:31]
    ds_read_b128 v[104:107], v7 offset:9216
    v_mfma_f32_16x16x32_bf16 v[32:35], v[128:131], v[76:79], v[32:35]
    ds_read_b128 v[108:111], v7 offset:10240
    v_mfma_f32_16x16x32_bf16 v[36:39], v[124:127], v[80:83], v[36:39]
    ds_read_b128 v[112:115], v7 offset:11264
    v_mfma_f32_16x16x32_bf16 v[40:43], v[128:131], v[80:83], v[40:43]
    ds_read_b128 v[116:119], v7 offset:12288
    v_mfma_f32_16x16x32_bf16 v[44:47], v[124:127], v[84:87], v[44:47]
    ds_read_b128 v[120:123], v7 offset:13312
    v_mfma_f32_16x16x32_bf16 v[48:51], v[128:131], v[84:87], v[48:51]
    v_mfma_f32_16x16x32_bf16 v[52:55], v[124:127], v[88:91], v[52:55]
    v_mfma_f32_16x16x32_bf16 v[56:59], v[128:131], v[88:91], v[56:59]
    v_mfma_f32_16x16x32_bf16 v[60:63], v[124:127], v[92:95], v[60:63]
    v_mfma_f32_16x16x32_bf16 v[64:67], v[128:131], v[92:95], v[64:67]
    s_waitcnt lgkmcnt(0)
    s_barrier
    v_mfma_f32_16x16x32_bf16 v[12:15], v[132:135], v[96:99], v[12:15]
    s_lshl_b32 s3, s14, 7
    s_add_u32 s3, s3, 159744
    v_add_u32 v3, s3, v238
    v_mfma_f32_16x16x32_bf16 v[16:19], v[136:139], v[96:99], v[16:19]
    v_add_u32 v4, 162304, v239
    ds_read_b128 v[196:199], v3 offset:0
    v_mfma_f32_16x16x32_bf16 v[20:23], v[132:135], v[100:103], v[20:23]
    ds_read_b128 v[200:203], v3 offset:64
    ds_read_b128 v[204:207], v3 offset:512
    v_mfma_f32_16x16x32_bf16 v[24:27], v[136:139], v[100:103], v[24:27]
    ds_read_b128 v[208:211], v3 offset:576
    ds_read_b128 v[212:215], v3 offset:1024
    v_mfma_f32_16x16x32_bf16 v[28:31], v[132:135], v[104:107], v[28:31]
    ds_read_b128 v[216:219], v3 offset:1088
    ds_read_b128 v[220:223], v3 offset:1536
    ds_read_b128 v[224:227], v3 offset:1600
    v_mfma_f32_16x16x32_bf16 v[32:35], v[136:139], v[104:107], v[32:35]
    ds_read_b32 v68, v4 offset:0
    ds_read_b32 v70, v4 offset:64
    v_mfma_f32_16x16x32_bf16 v[36:39], v[132:135], v[108:111], v[36:39]
    ds_read_b32 v72, v4 offset:128
    ds_read_b32 v74, v4 offset:192
    v_mfma_f32_16x16x32_bf16 v[40:43], v[136:139], v[108:111], v[40:43]
    ds_read_b32 v76, v4 offset:256
    ds_read_b32 v78, v4 offset:320
    v_mfma_f32_16x16x32_bf16 v[44:47], v[132:135], v[112:115], v[44:47]
    ds_read_b32 v80, v4 offset:384
    v_add_u32 v9, s39, v8
    s_add_u32 s39, s39, 16384
    v_mfma_f32_16x16x32_bf16 v[48:51], v[136:139], v[112:115], v[48:51]
    s_cmp_eq_u32 s39, 81920
    s_cselect_b32 s39, 0, s39
    v_mfma_f32_16x16x32_bf16 v[52:55], v[132:135], v[116:119], v[52:55]
    v_add_u32 v7, s38, v6
    s_add_u32 s38, s38, 14336
    v_mfma_f32_16x16x32_bf16 v[56:59], v[136:139], v[116:119], v[56:59]
    s_cmp_eq_u32 s38, 153600
    s_cselect_b32 s38, 81920, s38
    v_mfma_f32_16x16x32_bf16 v[60:63], v[132:135], v[120:123], v[60:63]
    v_mfma_f32_16x16x32_bf16 v[64:67], v[136:139], v[120:123], v[64:67]
    s_waitcnt lgkmcnt(0)
    .p2align 3
L_warm_a:
    v_pk_fma_f32 v[12:13], v[68:69], v[196:197], v[12:13] op_sel:[0,0,0] op_sel_hi:[0,1,1]
    v_pk_fma_f32 v[14:15], v[68:69], v[198:199], v[14:15] op_sel:[0,0,0] op_sel_hi:[0,1,1]
    v_pk_fma_f32 v[16:17], v[68:69], v[200:201], v[16:17] op_sel:[0,0,0] op_sel_hi:[0,1,1]
    v_pk_fma_f32 v[18:19], v[68:69], v[202:203], v[18:19] op_sel:[0,0,0] op_sel_hi:[0,1,1]
    v_pk_mul_f32 v[228:229], v[12:13], v[12:13]
    v_pk_mul_f32 v[230:231], v[14:15], v[14:15]
    v_pk_mul_f32 v[232:233], v[16:17], v[16:17]
    v_pk_mul_f32 v[234:235], v[18:19], v[18:19]
    v_pk_fma_f32 v[228:229], v[228:229], v[204:205], v[212:213] op_sel:[0,0,0] op_sel_hi:[1,1,1]
    v_pk_fma_f32 v[230:231], v[230:231], v[206:207], v[214:215] op_sel:[0,0,0] op_sel_hi:[1,1,1]
    v_pk_fma_f32 v[232:233], v[232:233], v[208:209], v[216:217] op_sel:[0,0,0] op_sel_hi:[1,1,1]
    v_pk_fma_f32 v[234:235], v[234:235], v[210:211], v[218:219] op_sel:[0,0,0] op_sel_hi:[1,1,1]
    v_pk_mul_f32 v[228:229], v[228:229], v[12:13]
    v_pk_mul_f32 v[230:231], v[230:231], v[14:15]
    v_pk_mul_f32 v[232:233], v[232:233], v[16:17]
    v_pk_mul_f32 v[234:235], v[234:235], v[18:19]
    v_exp_f32 v228, v228
    v_exp_f32 v229, v229
    v_exp_f32 v230, v230
    v_exp_f32 v231, v231
    v_exp_f32 v232, v232
    v_exp_f32 v233, v233
    v_exp_f32 v234, v234
    v_exp_f32 v235, v235
    v_pk_fma_f32 v[228:229], v[228:229], v[220:221], v[220:221] op_sel:[0,0,0] op_sel_hi:[1,1,1]
    v_pk_fma_f32 v[230:231], v[230:231], v[222:223], v[222:223] op_sel:[0,0,0] op_sel_hi:[1,1,1]
    v_pk_fma_f32 v[232:233], v[232:233], v[224:225], v[224:225] op_sel:[0,0,0] op_sel_hi:[1,1,1]
    v_pk_fma_f32 v[234:235], v[234:235], v[226:227], v[226:227] op_sel:[0,0,0] op_sel_hi:[1,1,1]
    v_rcp_f32 v228, v228
    v_rcp_f32 v229, v229
    v_rcp_f32 v230, v230
    v_rcp_f32 v231, v231
    v_rcp_f32 v232, v232
    v_rcp_f32 v233, v233
    v_rcp_f32 v234, v234
    v_rcp_f32 v235, v235
    v_pk_mul_f32 v[12:13], v[12:13], v[228:229]
    v_pk_mul_f32 v[14:15], v[14:15], v[230:231]
    v_pk_mul_f32 v[16:17], v[16:17], v[232:233]
    v_pk_mul_f32 v[18:19], v[18:19], v[234:235]
    v_pk_mul_f32 v[132:133], v[12:13], v[12:13]
    v_pk_mul_f32 v[134:135], v[14:15], v[14:15]
    v_pk_mul_f32 v[136:137], v[16:17], v[16:17]
    v_pk_mul_f32 v[138:139], v[18:19], v[18:19]
    v_pk_fma_f32 v[20:21], v[70:71], v[196:197], v[20:21] op_sel:[0,0,0] op_sel_hi:[0,1,1]
    v_pk_fma_f32 v[22:23], v[70:71], v[198:199], v[22:23] op_sel:[0,0,0] op_sel_hi:[0,1,1]
    v_pk_fma_f32 v[24:25], v[70:71], v[200:201], v[24:25] op_sel:[0,0,0] op_sel_hi:[0,1,1]
    v_pk_fma_f32 v[26:27], v[70:71], v[202:203], v[26:27] op_sel:[0,0,0] op_sel_hi:[0,1,1]
    v_pk_mul_f32 v[228:229], v[20:21], v[20:21]
    v_pk_mul_f32 v[230:231], v[22:23], v[22:23]
    v_pk_mul_f32 v[232:233], v[24:25], v[24:25]
    v_pk_mul_f32 v[234:235], v[26:27], v[26:27]
    v_pk_fma_f32 v[228:229], v[228:229], v[204:205], v[212:213] op_sel:[0,0,0] op_sel_hi:[1,1,1]
    v_pk_fma_f32 v[230:231], v[230:231], v[206:207], v[214:215] op_sel:[0,0,0] op_sel_hi:[1,1,1]
    v_pk_fma_f32 v[232:233], v[232:233], v[208:209], v[216:217] op_sel:[0,0,0] op_sel_hi:[1,1,1]
    v_pk_fma_f32 v[234:235], v[234:235], v[210:211], v[218:219] op_sel:[0,0,0] op_sel_hi:[1,1,1]
    v_pk_mul_f32 v[228:229], v[228:229], v[20:21]
    v_pk_mul_f32 v[230:231], v[230:231], v[22:23]
    v_pk_mul_f32 v[232:233], v[232:233], v[24:25]
    v_pk_mul_f32 v[234:235], v[234:235], v[26:27]
    v_exp_f32 v228, v228
    v_exp_f32 v229, v229
    v_exp_f32 v230, v230
    v_exp_f32 v231, v231
    v_exp_f32 v232, v232
    v_exp_f32 v233, v233
    v_exp_f32 v234, v234
    v_exp_f32 v235, v235
    v_pk_fma_f32 v[228:229], v[228:229], v[220:221], v[220:221] op_sel:[0,0,0] op_sel_hi:[1,1,1]
    v_pk_fma_f32 v[230:231], v[230:231], v[222:223], v[222:223] op_sel:[0,0,0] op_sel_hi:[1,1,1]
    v_pk_fma_f32 v[232:233], v[232:233], v[224:225], v[224:225] op_sel:[0,0,0] op_sel_hi:[1,1,1]
    v_pk_fma_f32 v[234:235], v[234:235], v[226:227], v[226:227] op_sel:[0,0,0] op_sel_hi:[1,1,1]
    v_rcp_f32 v228, v228
    v_rcp_f32 v229, v229
    v_rcp_f32 v230, v230
    v_rcp_f32 v231, v231
    v_rcp_f32 v232, v232
    v_rcp_f32 v233, v233
    v_rcp_f32 v234, v234
    v_rcp_f32 v235, v235
    v_pk_mul_f32 v[20:21], v[20:21], v[228:229]
    v_pk_mul_f32 v[22:23], v[22:23], v[230:231]
    v_pk_mul_f32 v[24:25], v[24:25], v[232:233]
    v_pk_mul_f32 v[26:27], v[26:27], v[234:235]
    v_pk_add_f32 v[124:125], v[12:13], v[20:21]
    v_pk_fma_f32 v[132:133], v[20:21], v[20:21], v[132:133]
    v_pk_add_f32 v[126:127], v[14:15], v[22:23]
    v_pk_fma_f32 v[134:135], v[22:23], v[22:23], v[134:135]
    v_pk_add_f32 v[128:129], v[16:17], v[24:25]
    v_pk_fma_f32 v[136:137], v[24:25], v[24:25], v[136:137]
    v_pk_add_f32 v[130:131], v[18:19], v[26:27]
    v_pk_fma_f32 v[138:139], v[26:27], v[26:27], v[138:139]
    v_pk_fma_f32 v[28:29], v[72:73], v[196:197], v[28:29] op_sel:[0,0,0] op_sel_hi:[0,1,1]
    v_pk_fma_f32 v[30:31], v[72:73], v[198:199], v[30:31] op_sel:[0,0,0] op_sel_hi:[0,1,1]
    v_pk_fma_f32 v[32:33], v[72:73], v[200:201], v[32:33] op_sel:[0,0,0] op_sel_hi:[0,1,1]
    v_pk_fma_f32 v[34:35], v[72:73], v[202:203], v[34:35] op_sel:[0,0,0] op_sel_hi:[0,1,1]
    v_pk_mul_f32 v[228:229], v[28:29], v[28:29]
    v_pk_mul_f32 v[230:231], v[30:31], v[30:31]
    v_pk_mul_f32 v[232:233], v[32:33], v[32:33]
    v_pk_mul_f32 v[234:235], v[34:35], v[34:35]
    v_pk_fma_f32 v[228:229], v[228:229], v[204:205], v[212:213] op_sel:[0,0,0] op_sel_hi:[1,1,1]
    v_pk_fma_f32 v[230:231], v[230:231], v[206:207], v[214:215] op_sel:[0,0,0] op_sel_hi:[1,1,1]
    v_pk_fma_f32 v[232:233], v[232:233], v[208:209], v[216:217] op_sel:[0,0,0] op_sel_hi:[1,1,1]
    v_pk_fma_f32 v[234:235], v[234:235], v[210:211], v[218:219] op_sel:[0,0,0] op_sel_hi:[1,1,1]
    v_pk_mul_f32 v[228:229], v[228:229], v[28:29]
    v_pk_mul_f32 v[230:231], v[230:231], v[30:31]
    v_pk_mul_f32 v[232:233], v[232:233], v[32:33]
    v_pk_mul_f32 v[234:235], v[234:235], v[34:35]
    v_exp_f32 v228, v228
    v_exp_f32 v229, v229
    v_exp_f32 v230, v230
    v_exp_f32 v231, v231
    v_exp_f32 v232, v232
    v_exp_f32 v233, v233
    v_exp_f32 v234, v234
    v_exp_f32 v235, v235
    v_pk_fma_f32 v[228:229], v[228:229], v[220:221], v[220:221] op_sel:[0,0,0] op_sel_hi:[1,1,1]
    v_pk_fma_f32 v[230:231], v[230:231], v[222:223], v[222:223] op_sel:[0,0,0] op_sel_hi:[1,1,1]
    v_pk_fma_f32 v[232:233], v[232:233], v[224:225], v[224:225] op_sel:[0,0,0] op_sel_hi:[1,1,1]
    v_pk_fma_f32 v[234:235], v[234:235], v[226:227], v[226:227] op_sel:[0,0,0] op_sel_hi:[1,1,1]
    v_rcp_f32 v228, v228
    v_rcp_f32 v229, v229
    v_rcp_f32 v230, v230
    v_rcp_f32 v231, v231
    v_rcp_f32 v232, v232
    v_rcp_f32 v233, v233
    v_rcp_f32 v234, v234
    v_rcp_f32 v235, v235
    v_pk_mul_f32 v[28:29], v[28:29], v[228:229]
    v_pk_mul_f32 v[30:31], v[30:31], v[230:231]
    v_pk_mul_f32 v[32:33], v[32:33], v[232:233]
    v_pk_mul_f32 v[34:35], v[34:35], v[234:235]
    v_pk_add_f32 v[124:125], v[124:125], v[28:29]
    v_pk_fma_f32 v[132:133], v[28:29], v[28:29], v[132:133]
    v_pk_add_f32 v[126:127], v[126:127], v[30:31]
    v_pk_fma_f32 v[134:135], v[30:31], v[30:31], v[134:135]
    v_pk_add_f32 v[128:129], v[128:129], v[32:33]
    v_pk_fma_f32 v[136:137], v[32:33], v[32:33], v[136:137]
    v_pk_add_f32 v[130:131], v[130:131], v[34:35]
    v_pk_fma_f32 v[138:139], v[34:35], v[34:35], v[138:139]
    v_pk_fma_f32 v[36:37], v[74:75], v[196:197], v[36:37] op_sel:[0,0,0] op_sel_hi:[0,1,1]
    v_pk_fma_f32 v[38:39], v[74:75], v[198:199], v[38:39] op_sel:[0,0,0] op_sel_hi:[0,1,1]
    v_pk_fma_f32 v[40:41], v[74:75], v[200:201], v[40:41] op_sel:[0,0,0] op_sel_hi:[0,1,1]
    v_pk_fma_f32 v[42:43], v[74:75], v[202:203], v[42:43] op_sel:[0,0,0] op_sel_hi:[0,1,1]
    v_pk_mul_f32 v[228:229], v[36:37], v[36:37]
    v_pk_mul_f32 v[230:231], v[38:39], v[38:39]
    v_pk_mul_f32 v[232:233], v[40:41], v[40:41]
    v_pk_mul_f32 v[234:235], v[42:43], v[42:43]
    v_pk_fma_f32 v[228:229], v[228:229], v[204:205], v[212:213] op_sel:[0,0,0] op_sel_hi:[1,1,1]
    v_pk_fma_f32 v[230:231], v[230:231], v[206:207], v[214:215] op_sel:[0,0,0] op_sel_hi:[1,1,1]
    v_pk_fma_f32 v[232:233], v[232:233], v[208:209], v[216:217] op_sel:[0,0,0] op_sel_hi:[1,1,1]
    v_pk_fma_f32 v[234:235], v[234:235], v[210:211], v[218:219] op_sel:[0,0,0] op_sel_hi:[1,1,1]
    v_pk_mul_f32 v[228:229], v[228:229], v[36:37]
    v_pk_mul_f32 v[230:231], v[230:231], v[38:39]
    v_pk_mul_f32 v[232:233], v[232:233], v[40:41]
    v_pk_mul_f32 v[234:235], v[234:235], v[42:43]
    v_exp_f32 v228, v228
    v_exp_f32 v229, v229
    v_exp_f32 v230, v230
    v_exp_f32 v231, v231
    v_exp_f32 v232, v232
    v_exp_f32 v233, v233
    v_exp_f32 v234, v234
    v_exp_f32 v235, v235
    v_pk_fma_f32 v[228:229], v[228:229], v[220:221], v[220:221] op_sel:[0,0,0] op_sel_hi:[1,1,1]
    v_pk_fma_f32 v[230:231], v[230:231], v[222:223], v[222:223] op_sel:[0,0,0] op_sel_hi:[1,1,1]
    v_pk_fma_f32 v[232:233], v[232:233], v[224:225], v[224:225] op_sel:[0,0,0] op_sel_hi:[1,1,1]
    v_pk_fma_f32 v[234:235], v[234:235], v[226:227], v[226:227] op_sel:[0,0,0] op_sel_hi:[1,1,1]
    v_rcp_f32 v228, v228
    v_rcp_f32 v229, v229
    v_rcp_f32 v230, v230
    v_rcp_f32 v231, v231
    v_rcp_f32 v232, v232
    v_rcp_f32 v233, v233
    v_rcp_f32 v234, v234
    v_rcp_f32 v235, v235
    v_pk_mul_f32 v[36:37], v[36:37], v[228:229]
    v_pk_mul_f32 v[38:39], v[38:39], v[230:231]
    v_pk_mul_f32 v[40:41], v[40:41], v[232:233]
    v_pk_mul_f32 v[42:43], v[42:43], v[234:235]
    v_pk_add_f32 v[124:125], v[124:125], v[36:37]
    v_pk_fma_f32 v[132:133], v[36:37], v[36:37], v[132:133]
    v_pk_add_f32 v[126:127], v[126:127], v[38:39]
    v_pk_fma_f32 v[134:135], v[38:39], v[38:39], v[134:135]
    v_pk_add_f32 v[128:129], v[128:129], v[40:41]
    v_pk_fma_f32 v[136:137], v[40:41], v[40:41], v[136:137]
    v_pk_add_f32 v[130:131], v[130:131], v[42:43]
    v_pk_fma_f32 v[138:139], v[42:43], v[42:43], v[138:139]
L_warm_b:
    v_pk_fma_f32 v[44:45], v[76:77], v[196:197], v[44:45] op_sel:[0,0,0] op_sel_hi:[0,1,1]
    v_pk_fma_f32 v[46:47], v[76:77], v[198:199], v[46:47] op_sel:[0,0,0] op_sel_hi:[0,1,1]
    v_pk_fma_f32 v[48:49], v[76:77], v[200:201], v[48:49] op_sel:[0,0,0] op_sel_hi:[0,1,1]
    v_pk_fma_f32 v[50:51], v[76:77], v[202:203], v[50:51] op_sel:[0,0,0] op_sel_hi:[0,1,1]
    v_pk_mul_f32 v[228:229], v[44:45], v[44:45]
    v_pk_mul_f32 v[230:231], v[46:47], v[46:47]
    v_pk_mul_f32 v[232:233], v[48:49], v[48:49]
    v_pk_mul_f32 v[234:235], v[50:51], v[50:51]
    v_pk_fma_f32 v[228:229], v[228:229], v[204:205], v[212:213] op_sel:[0,0,0] op_sel_hi:[1,1,1]
    v_pk_fma_f32 v[230:231], v[230:231], v[206:207], v[214:215] op_sel:[0,0,0] op_sel_hi:[1,1,1]
    v_pk_fma_f32 v[232:233], v[232:233], v[208:209], v[216:217] op_sel:[0,0,0] op_sel_hi:[1,1,1]
    v_pk_fma_f32 v[234:235], v[234:235], v[210:211], v[218:219] op_sel:[0,0,0] op_sel_hi:[1,1,1]
    v_pk_mul_f32 v[228:229], v[228:229], v[44:45]
    v_pk_mul_f32 v[230:231], v[230:231], v[46:47]
    v_pk_mul_f32 v[232:233], v[232:233], v[48:49]
    v_pk_mul_f32 v[234:235], v[234:235], v[50:51]
    v_exp_f32 v228, v228
    v_exp_f32 v229, v229
    v_exp_f32 v230, v230
    v_exp_f32 v231, v231
    v_exp_f32 v232, v232
    v_exp_f32 v233, v233
    v_exp_f32 v234, v234
    v_exp_f32 v235, v235
    v_pk_fma_f32 v[228:229], v[228:229], v[220:221], v[220:221] op_sel:[0,0,0] op_sel_hi:[1,1,1]
    v_pk_fma_f32 v[230:231], v[230:231], v[222:223], v[222:223] op_sel:[0,0,0] op_sel_hi:[1,1,1]
    v_pk_fma_f32 v[232:233], v[232:233], v[224:225], v[224:225] op_sel:[0,0,0] op_sel_hi:[1,1,1]
    v_pk_fma_f32 v[234:235], v[234:235], v[226:227], v[226:227] op_sel:[0,0,0] op_sel_hi:[1,1,1]
    v_rcp_f32 v228, v228
    v_rcp_f32 v229, v229
    v_rcp_f32 v230, v230
    v_rcp_f32 v231, v231
    v_rcp_f32 v232, v232
    v_rcp_f32 v233, v233
    v_rcp_f32 v234, v234
    v_rcp_f32 v235, v235
    v_pk_mul_f32 v[44:45], v[44:45], v[228:229]
    v_pk_mul_f32 v[46:47], v[46:47], v[230:231]
    v_pk_mul_f32 v[48:49], v[48:49], v[232:233]
    v_pk_mul_f32 v[50:51], v[50:51], v[234:235]
    v_pk_add_f32 v[124:125], v[124:125], v[44:45]
    v_pk_fma_f32 v[132:133], v[44:45], v[44:45], v[132:133]
    v_pk_add_f32 v[126:127], v[126:127], v[46:47]
    v_pk_fma_f32 v[134:135], v[46:47], v[46:47], v[134:135]
    v_pk_add_f32 v[128:129], v[128:129], v[48:49]
    v_pk_fma_f32 v[136:137], v[48:49], v[48:49], v[136:137]
    v_pk_add_f32 v[130:131], v[130:131], v[50:51]
    v_pk_fma_f32 v[138:139], v[50:51], v[50:51], v[138:139]
    v_pk_fma_f32 v[52:53], v[78:79], v[196:197], v[52:53] op_sel:[0,0,0] op_sel_hi:[0,1,1]
    v_pk_fma_f32 v[54:55], v[78:79], v[198:199], v[54:55] op_sel:[0,0,0] op_sel_hi:[0,1,1]
    v_pk_fma_f32 v[56:57], v[78:79], v[200:201], v[56:57] op_sel:[0,0,0] op_sel_hi:[0,1,1]
    v_pk_fma_f32 v[58:59], v[78:79], v[202:203], v[58:59] op_sel:[0,0,0] op_sel_hi:[0,1,1]
    v_pk_mul_f32 v[228:229], v[52:53], v[52:53]
    v_pk_mul_f32 v[230:231], v[54:55], v[54:55]
    v_pk_mul_f32 v[232:233], v[56:57], v[56:57]
    v_pk_mul_f32 v[234:235], v[58:59], v[58:59]
    v_pk_fma_f32 v[228:229], v[228:229], v[204:205], v[212:213] op_sel:[0,0,0] op_sel_hi:[1,1,1]
    v_pk_fma_f32 v[230:231], v[230:231], v[206:207], v[214:215] op_sel:[0,0,0] op_sel_hi:[1,1,1]
    v_pk_fma_f32 v[232:233], v[232:233], v[208:209], v[216:217] op_sel:[0,0,0] op_sel_hi:[1,1,1]
    v_pk_fma_f32 v[234:235], v[234:235], v[210:211], v[218:219] op_sel:[0,0,0] op_sel_hi:[1,1,1]
    v_pk_mul_f32 v[228:229], v[228:229], v[52:53]
    v_pk_mul_f32 v[230:231], v[230:231], v[54:55]
    v_pk_mul_f32 v[232:233], v[232:233], v[56:57]
    v_pk_mul_f32 v[234:235], v[234:235], v[58:59]
    v_exp_f32 v228, v228
    v_exp_f32 v229, v229
    v_exp_f32 v230, v230
    v_exp_f32 v231, v231
    v_exp_f32 v232, v232
    v_exp_f32 v233, v233
    v_exp_f32 v234, v234
    v_exp_f32 v235, v235
    v_pk_fma_f32 v[228:229], v[228:229], v[220:221], v[220:221] op_sel:[0,0,0] op_sel_hi:[1,1,1]
    v_pk_fma_f32 v[230:231], v[230:231], v[222:223], v[222:223] op_sel:[0,0,0] op_sel_hi:[1,1,1]
    v_pk_fma_f32 v[232:233], v[232:233], v[224:225], v[224:225] op_sel:[0,0,0] op_sel_hi:[1,1,1]
    v_pk_fma_f32 v[234:235], v[234:235], v[226:227], v[226:227] op_sel:[0,0,0] op_sel_hi:[1,1,1]
    v_rcp_f32 v228, v228
    v_rcp_f32 v229, v229
    v_rcp_f32 v230, v230
    v_rcp_f32 v231, v231
    v_rcp_f32 v232, v232
    v_rcp_f32 v233, v233
    v_rcp_f32 v234, v234
    v_rcp_f32 v235, v235
    v_pk_mul_f32 v[52:53], v[52:53], v[228:229]
    v_pk_mul_f32 v[54:55], v[54:55], v[230:231]
    v_pk_mul_f32 v[56:57], v[56:57], v[232:233]
    v_pk_mul_f32 v[58:59], v[58:59], v[234:235]
    v_pk_add_f32 v[124:125], v[124:125], v[52:53]
    v_pk_fma_f32 v[132:133], v[52:53], v[52:53], v[132:133]
    v_pk_add_f32 v[126:127], v[126:127], v[54:55]
    v_pk_fma_f32 v[134:135], v[54:55], v[54:55], v[134:135]
    v_pk_add_f32 v[128:129], v[128:129], v[56:57]
    v_pk_fma_f32 v[136:137], v[56:57], v[56:57], v[136:137]
    v_pk_add_f32 v[130:131], v[130:131], v[58:59]
    v_pk_fma_f32 v[138:139], v[58:59], v[58:59], v[138:139]
    v_pk_fma_f32 v[60:61], v[80:81], v[196:197], v[60:61] op_sel:[0,0,0] op_sel_hi:[0,1,1]
    v_pk_fma_f32 v[62:63], v[80:81], v[198:199], v[62:63] op_sel:[0,0,0] op_sel_hi:[0,1,1]
    v_pk_fma_f32 v[64:65], v[80:81], v[200:201], v[64:65] op_sel:[0,0,0] op_sel_hi:[0,1,1]
    v_pk_fma_f32 v[66:67], v[80:81], v[202:203], v[66:67] op_sel:[0,0,0] op_sel_hi:[0,1,1]
    v_pk_mul_f32 v[228:229], v[60:61], v[60:61]
    v_pk_mul_f32 v[230:231], v[62:63], v[62:63]
    v_pk_mul_f32 v[232:233], v[64:65], v[64:65]
    v_pk_mul_f32 v[234:235], v[66:67], v[66:67]
    v_pk_fma_f32 v[228:229], v[228:229], v[204:205], v[212:213] op_sel:[0,0,0] op_sel_hi:[1,1,1]
    v_pk_fma_f32 v[230:231], v[230:231], v[206:207], v[214:215] op_sel:[0,0,0] op_sel_hi:[1,1,1]
    v_pk_fma_f32 v[232:233], v[232:233], v[208:209], v[216:217] op_sel:[0,0,0] op_sel_hi:[1,1,1]
    v_pk_fma_f32 v[234:235], v[234:235], v[210:211], v[218:219] op_sel:[0,0,0] op_sel_hi:[1,1,1]
    v_pk_mul_f32 v[228:229], v[228:229], v[60:61]
    v_pk_mul_f32 v[230:231], v[230:231], v[62:63]
    v_pk_mul_f32 v[232:233], v[232:233], v[64:65]
    v_pk_mul_f32 v[234:235], v[234:235], v[66:67]
    v_exp_f32 v228, v228
    v_exp_f32 v229, v229
    v_exp_f32 v230, v230
    v_exp_f32 v231, v231
    v_exp_f32 v232, v232
    v_exp_f32 v233, v233
    v_exp_f32 v234, v234
    v_exp_f32 v235, v235
    v_pk_fma_f32 v[228:229], v[228:229], v[220:221], v[220:221] op_sel:[0,0,0] op_sel_hi:[1,1,1]
    v_pk_fma_f32 v[230:231], v[230:231], v[222:223], v[222:223] op_sel:[0,0,0] op_sel_hi:[1,1,1]
    v_pk_fma_f32 v[232:233], v[232:233], v[224:225], v[224:225] op_sel:[0,0,0] op_sel_hi:[1,1,1]
    v_pk_fma_f32 v[234:235], v[234:235], v[226:227], v[226:227] op_sel:[0,0,0] op_sel_hi:[1,1,1]
    v_rcp_f32 v228, v228
    v_rcp_f32 v229, v229
    v_rcp_f32 v230, v230
    v_rcp_f32 v231, v231
    v_rcp_f32 v232, v232
    v_rcp_f32 v233, v233
    v_rcp_f32 v234, v234
    v_rcp_f32 v235, v235
    v_pk_mul_f32 v[60:61], v[60:61], v[228:229]
    v_pk_mul_f32 v[62:63], v[62:63], v[230:231]
    v_pk_mul_f32 v[64:65], v[64:65], v[232:233]
    v_pk_mul_f32 v[66:67], v[66:67], v[234:235]
    v_pk_add_f32 v[124:125], v[124:125], v[60:61]
    v_pk_fma_f32 v[132:133], v[60:61], v[60:61], v[132:133]
    v_pk_add_f32 v[126:127], v[126:127], v[62:63]
    v_pk_fma_f32 v[134:135], v[62:63], v[62:63], v[134:135]
    v_pk_add_f32 v[128:129], v[128:129], v[64:65]
    v_pk_fma_f32 v[136:137], v[64:65], v[64:65], v[136:137]
    v_pk_add_f32 v[130:131], v[130:131], v[66:67]
    v_pk_fma_f32 v[138:139], v[66:67], v[66:67], v[138:139]
    s_nop 1
    v_add_f32_dpp v228, v124, v124 row_ror:8 row_mask:0xf bank_mask:0x3
    v_add_f32_dpp v232, v132, v132 row_ror:8 row_mask:0xf bank_mask:0x3
    v_add_f32_dpp v229, v125, v125 row_ror:8 row_mask:0xf bank_mask:0x3
    v_add_f32_dpp v233, v133, v133 row_ror:8 row_mask:0xf bank_mask:0x3
    v_add_f32_dpp v230, v126, v126 row_ror:8 row_mask:0xf bank_mask:0x3
    v_add_f32_dpp v234, v134, v134 row_ror:8 row_mask:0xf bank_mask:0x3
    v_add_f32_dpp v231, v127, v127 row_ror:8 row_mask:0xf bank_mask:0x3
    v_add_f32_dpp v235, v135, v135 row_ror:8 row_mask:0xf bank_mask:0x3
    v_add_f32_dpp v228, v128, v128 row_ror:8 row_mask:0xf bank_mask:0xc
    v_add_f32_dpp v232, v136, v136 row_ror:8 row_mask:0xf bank_mask:0xc
    v_add_f32_dpp v229, v129, v129 row_ror:8 row_mask:0xf bank_mask:0xc
    v_add_f32_dpp v233, v137, v137 row_ror:8 row_mask:0xf bank_mask:0xc
    v_add_f32_dpp v230, v130, v130 row_ror:8 row_mask:0xf bank_mask:0xc
    v_add_f32_dpp v234, v138, v138 row_ror:8 row_mask:0xf bank_mask:0xc
    v_add_f32_dpp v231, v131, v131 row_ror:8 row_mask:0xf bank_mask:0xc
    v_add_f32_dpp v235, v139, v139 row_ror:8 row_mask:0xf bank_mask:0xc
    v_add_f32_dpp v124, v228, v228 row_half_mirror row_mask:0xf bank_mask:0x5
    v_add_f32_dpp v125, v232, v232 row_half_mirror row_mask:0xf bank_mask:0x5
    v_add_f32_dpp v126, v229, v229 row_half_mirror row_mask:0xf bank_mask:0x5
    v_add_f32_dpp v127, v233, v233 row_half_mirror row_mask:0xf bank_mask:0x5
    v_add_f32_dpp v124, v230, v230 row_half_mirror row_mask:0xf bank_mask:0xa
    v_add_f32_dpp v125, v234, v234 row_half_mirror row_mask:0xf bank_mask:0xa
    v_add_f32_dpp v126, v231, v231 row_half_mirror row_mask:0xf bank_mask:0xa
    v_add_f32_dpp v127, v235, v235 row_half_mirror row_mask:0xf bank_mask:0xa
    v_add_f32_dpp v124, v124, v124 quad_perm:[1,0,3,2] row_mask:0xf bank_mask:0xf
    v_add_f32_dpp v125, v125, v125 quad_perm:[1,0,3,2] row_mask:0xf bank_mask:0xf
    v_add_f32_dpp v126, v126, v126 quad_perm:[1,0,3,2] row_mask:0xf bank_mask:0xf
    v_add_f32_dpp v127, v127, v127 quad_perm:[1,0,3,2] row_mask:0xf bank_mask:0xf
    v_add_f32_dpp v124, v124, v124 quad_perm:[2,3,0,1] row_mask:0xf bank_mask:0xf
    v_add_f32_dpp v125, v125, v125 quad_perm:[2,3,0,1] row_mask:0xf bank_mask:0xf
    v_add_f32_dpp v126, v126, v126 quad_perm:[2,3,0,1] row_mask:0xf bank_mask:0xf
    v_add_f32_dpp v127, v127, v127 quad_perm:[2,3,0,1] row_mask:0xf bank_mask:0xf
    v_bfe_u32 v3, v1, 3, 1
    v_lshlrev_b32 v3, 7, v3
    v_lshl_add_u32 v3, v238, 1, v3
    v_bfe_u32 v4, v1, 2, 1
    v_lshl_add_u32 v3, v4, 4, v3
    v_and_b32 v125, 0x7fffffff, v125
    v_and_b32 v127, 0x7fffffff, v127
    s_lshl_b32 s48, s34, 14
    s_lshl_b32 s3, s14, 8
    s_add_u32 s48, s48, s3
    s_add_u32 s48, s48, 29360128
    s_lshl_b32 s3, s35, 10
    s_add_u32 s3, s3, s48
    s_mov_b32 exec_lo, 0x11111111
    s_mov_b32 exec_hi, 0x11111111
    buffer_store_dwordx4 v[124:127], v3, s[20:23], s3 offen sc1
    s_mov_b64 exec, -1
    s_add_u32 s49, s48, 4096
    s_add_u32 s50, s48, 8192
    s_add_u32 s51, s48, 12288
    v_lshlrev_b32 v5, 6, v238
    v_lshl_add_u32 v5, v239, 2, v5
    s_barrier
    ds_read_b128 v[124:127], v9 offset:0
    ds_read_b128 v[128:131], v9 offset:1024
    ds_read_b128 v[68:71], v7 offset:0
    ds_read_b128 v[72:75], v7 offset:1024
    ds_read_b128 v[76:79], v7 offset:2048
    ds_read_b128 v[80:83], v7 offset:3072
    ds_read_b128 v[84:87], v7 offset:4096
    ds_read_b128 v[88:91], v7 offset:5120
    ds_read_b128 v[92:95], v7 offset:6144
    s_mov_b32 s15, 15
L_loop_49:
    s_bitcmp1_b32 0x14c0, s15
    s_cbranch_scc1 L_hook_51
L_back_50:
    s_waitcnt lgkmcnt(0)
    v_mfma_f32_16x16x32_bf16 v[140:143], v[68:71], v[124:127], v[140:143]
    ds_read_b128 v[132:135], v9 offset:8192
    ds_read_b128 v[136:139], v9 offset:9216
    v_mfma_f32_16x16x32_bf16 v[144:147], v[68:71], v[128:131], v[144:147]
    ds_read_b128 v[96:99], v7 offset:7168
    ds_read_b128 v[100:103], v7 offset:8192
    v_mfma_f32_16x16x32_bf16 v[148:151], v[72:75], v[124:127], v[148:151]
    ds_read_b128 v[104:107], v7 offset:9216
    ds_read_b128 v[108:111], v7 offset:10240
    v_mfma_f32_16x16x32_bf16 v[152:155], v[72:75], v[128:131], v[152:155]
    ds_read_b128 v[112:115], v7 offset:11264
    v_mfma_f32_16x16x32_bf16 v[156:159], v[76:79], v[124:127], v[156:159]
    ds_read_b128 v[116:119], v7 offset:12288
    ds_read_b128 v[120:123], v7 offset:13312
    v_mfma_f32_16x16x32_bf16 v[160:163], v[76:79], v[128:131], v[160:163]
    v_add_u32 v9, s39, v8
    s_add_u32 s39, s39, 16384
    v_mfma_f32_16x16x32_bf16 v[164:167], v[80:83], v[124:127], v[164:167]
    s_cmp_eq_u32 s39, 81920
    v_mfma_f32_16x16x32_bf16 v[168:171], v[80:83], v[128:131], v[168:171]
    s_cselect_b32 s39, 0, s39
    v_add_u32 v7, s38, v6
    v_mfma_f32_16x16x32_bf16 v[172:175], v[84:87], v[124:127], v[172:175]
    s_add_u32 s38, s38, 14336
    s_cmp_eq_u32 s38, 153600
    v_mfma_f32_16x16x32_bf16 v[176:179], v[84:87], v[128:131], v[176:179]
    s_cselect_b32 s38, 81920, s38
    v_mfma_f32_16x16x32_bf16 v[180:183], v[88:91], v[124:127], v[180:183]
    v_mfma_f32_16x16x32_bf16 v[184:187], v[88:91], v[128:131], v[184:187]
    v_mfma_f32_16x16x32_bf16 v[188:191], v[92:95], v[124:127], v[188:191]
    v_mfma_f32_16x16x32_bf16 v[192:195], v[92:95], v[128:131], v[192:195]
    s_waitcnt lgkmcnt(0)
    s_barrier
    v_mfma_f32_16x16x32_bf16 v[140:143], v[96:99], v[132:135], v[140:143]
    ds_read_b128 v[124:127], v9 offset:0
    ds_read_b128 v[128:131], v9 offset:1024
    v_mfma_f32_16x16x32_bf16 v[144:147], v[96:99], v[136:139], v[144:147]
    ds_read_b128 v[68:71], v7 offset:0
    v_mfma_f32_16x16x32_bf16 v[148:151], v[100:103], v[132:135], v[148:151]
    ds_read_b128 v[72:75], v7 offset:1024
    v_mfma_f32_16x16x32_bf16 v[152:155], v[100:103], v[136:139], v[152:155]
    ds_read_b128 v[76:79], v7 offset:2048
    v_mfma_f32_16x16x32_bf16 v[156:159], v[104:107], v[132:135], v[156:159]
    ds_read_b128 v[80:83], v7 offset:3072
    v_mfma_f32_16x16x32_bf16 v[160:163], v[104:107], v[136:139], v[160:163]
    ds_read_b128 v[84:87], v7 offset:4096
    v_mfma_f32_16x16x32_bf16 v[164:167], v[108:111], v[132:135], v[164:167]
    ds_read_b128 v[88:91], v7 offset:5120
    v_mfma_f32_16x16x32_bf16 v[168:171], v[108:111], v[136:139], v[168:171]
    ds_read_b128 v[92:95], v7 offset:6144
    v_mfma_f32_16x16x32_bf16 v[172:175], v[112:115], v[132:135], v[172:175]
    s_sub_u32 s15, s15, 1
    v_mfma_f32_16x16x32_bf16 v[176:179], v[112:115], v[136:139], v[176:179]
    s_cmp_lg_u32 s15, 0
    v_mfma_f32_16x16x32_bf16 v[180:183], v[116:119], v[132:135], v[180:183]
    v_mfma_f32_16x16x32_bf16 v[184:187], v[116:119], v[136:139], v[184:187]
    v_mfma_f32_16x16x32_bf16 v[188:191], v[120:123], v[132:135], v[188:191]
    v_mfma_f32_16x16x32_bf16 v[192:195], v[120:123], v[136:139], v[192:195]
    s_cbranch_scc1 L_loop_49
    s_waitcnt lgkmcnt(0)
    v_mfma_f32_16x16x32_bf16 v[140:143], v[68:71], v[124:127], v[140:143]
    ds_read_b128 v[132:135], v9 offset:8192
    v_mfma_f32_16x16x32_bf16 v[144:147], v[68:71], v[128:131], v[144:147]
    ds_read_b128 v[136:139], v9 offset:9216
    v_mfma_f32_16x16x32_bf16 v[148:151], v[72:75], v[124:127], v[148:151]
    ds_read_b128 v[96:99], v7 offset:7168
    v_mfma_f32_16x16x32_bf16 v[152:155], v[72:75], v[128:131], v[152:155]
    ds_read_b128 v[100:103], v7 offset:8192
    v_mfma_f32_16x16x32_bf16 v[156:159], v[76:79], v[124:127], v[156:159]
    ds_read_b128 v[104:107], v7 offset:9216
    v_mfma_f32_16x16x32_bf16 v[160:163], v[76:79], v[128:131], v[160:163]
    ds_read_b128 v[108:111], v7 offset:10240
    v_mfma_f32_16x16x32_bf16 v[164:167], v[80:83], v[124:127], v[164:167]
    ds_read_b128 v[112:115], v7 offset:11264
    v_mfma_f32_16x16x32_bf16 v[168:171], v[80:83], v[128:131], v[168:171]
    ds_read_b128 v[116:119], v7 offset:12288
    v_mfma_f32_16x16x32_bf16 v[172:175], v[84:87], v[124:127], v[172:175]
    ds_read_b128 v[120:123], v7 offset:13312
    v_mfma_f32_16x16x32_bf16 v[176:179], v[84:87], v[128:131], v[176:179]
    v_mfma_f32_16x16x32_bf16 v[180:183], v[88:91], v[124:127], v[180:183]
    v_mfma_f32_16x16x32_bf16 v[184:187], v[88:91], v[128:131], v[184:187]
    v_mfma_f32_16x16x32_bf16 v[188:191], v[92:95], v[124:127], v[188:191]
    v_mfma_f32_16x16x32_bf16 v[192:195], v[92:95], v[128:131], v[192:195]
    s_waitcnt lgkmcnt(0)
    s_barrier
    v_mfma_f32_16x16x32_bf16 v[140:143], v[96:99], v[132:135], v[140:143]
    v_add_u32 v3, 161792, v238
    s_lshl_b32 s3, s14, 9
    v_mfma_f32_16x16x32_bf16 v[144:147], v[96:99], v[136:139], v[144:147]
    s_add_u32 s3, s3, 157696
    v_lshl_add_u32 v4, v239, 2, s3
    v_mfma_f32_16x16x32_bf16 v[148:151], v[100:103], v[132:135], v[148:151]
    ds_read_b128 v[124:127], v4 offset:0
    ds_read_b128 v[128:131], v4 offset:256
    v_mfma_f32_16x16x32_bf16 v[152:155], v[100:103], v[136:139], v[152:155]
    ds_read_b128 v[68:71], v3 offset:0
    v_mfma_f32_16x16x32_bf16 v[156:159], v[104:107], v[132:135], v[156:159]
    ds_read_b128 v[72:75], v3 offset:64
    ds_read_b128 v[76:79], v3 offset:128
    v_mfma_f32_16x16x32_bf16 v[160:163], v[104:107], v[136:139], v[160:163]
    ds_read_b128 v[80:83], v3 offset:192
    ds_read_b128 v[84:87], v3 offset:256
    v_mfma_f32_16x16x32_bf16 v[164:167], v[108:111], v[132:135], v[164:167]
    ds_read_b128 v[88:91], v3 offset:320
    ds_read_b128 v[92:95], v3 offset:384
    v_mfma_f32_16x16x32_bf16 v[168:171], v[108:111], v[136:139], v[168:171]
    v_add_u32 v9, s39, v8
    v_mfma_f32_16x16x32_bf16 v[172:175], v[112:115], v[132:135], v[172:175]
    s_add_u32 s39, s39, 16384
    s_cmp_eq_u32 s39, 81920
    v_mfma_f32_16x16x32_bf16 v[176:179], v[112:115], v[136:139], v[176:179]
    s_cselect_b32 s39, 0, s39
    v_add_u32 v7, s38, v6
    v_mfma_f32_16x16x32_bf16 v[180:183], v[116:119], v[132:135], v[180:183]
    s_add_u32 s38, s38, 14336
    s_cmp_eq_u32 s38, 153600
    v_mfma_f32_16x16x32_bf16 v[184:187], v[116:119], v[136:139], v[184:187]
    s_cselect_b32 s38, 81920, s38
    v_mfma_f32_16x16x32_bf16 v[188:191], v[120:123], v[132:135], v[188:191]
    v_mfma_f32_16x16x32_bf16 v[192:195], v[120:123], v[136:139], v[192:195]
    s_waitcnt lgkmcnt(0)
    .p2align 3
L_warm_c:
    v_pk_fma_f32 v[140:141], v[68:69], v[124:125], v[140:141] op_sel:[0,0,0] op_sel_hi:[1,0,1]
    v_pk_fma_f32 v[142:143], v[70:71], v[124:125], v[142:143] op_sel:[0,0,0] op_sel_hi:[1,0,1]
    v_pk_fma_f32 v[144:145], v[68:69], v[128:129], v[144:145] op_sel:[0,0,0] op_sel_hi:[1,0,1]
    v_pk_fma_f32 v[146:147], v[70:71], v[128:129], v[146:147] op_sel:[0,0,0] op_sel_hi:[1,0,1]
    v_pk_mul_f32 v[228:229], v[140:141], v[140:141]
    v_pk_mul_f32 v[230:231], v[142:143], v[142:143]
    v_pk_mul_f32 v[232:233], v[144:145], v[144:145]
    v_pk_mul_f32 v[234:235], v[146:147], v[146:147]
    v_pk_fma_f32 v[228:229], v[228:229], v[124:125], v[126:127] op_sel:[0,1,0] op_sel_hi:[1,1,0]
    v_pk_fma_f32 v[230:231], v[230:231], v[124:125], v[126:127] op_sel:[0,1,0] op_sel_hi:[1,1,0]
    v_pk_fma_f32 v[232:233], v[232:233], v[128:129], v[130:131] op_sel:[0,1,0] op_sel_hi:[1,1,0]
    v_pk_fma_f32 v[234:235], v[234:235], v[128:129], v[130:131] op_sel:[0,1,0] op_sel_hi:[1,1,0]
    v_pk_mul_f32 v[228:229], v[228:229], v[140:141]
    v_pk_mul_f32 v[230:231], v[230:231], v[142:143]
    v_pk_mul_f32 v[232:233], v[232:233], v[144:145]
    v_pk_mul_f32 v[234:235], v[234:235], v[146:147]
    v_exp_f32 v228, v228
    v_exp_f32 v229, v229
    v_exp_f32 v230, v230
    v_exp_f32 v231, v231
    v_exp_f32 v232, v232
    v_exp_f32 v233, v233
    v_exp_f32 v234, v234
    v_exp_f32 v235, v235
    v_pk_fma_f32 v[228:229], v[228:229], v[126:127], v[126:127] op_sel:[0,1,1] op_sel_hi:[1,1,1]
    v_pk_fma_f32 v[230:231], v[230:231], v[126:127], v[126:127] op_sel:[0,1,1] op_sel_hi:[1,1,1]
    v_pk_fma_f32 v[232:233], v[232:233], v[130:131], v[130:131] op_sel:[0,1,1] op_sel_hi:[1,1,1]
    v_pk_fma_f32 v[234:235], v[234:235], v[130:131], v[130:131] op_sel:[0,1,1] op_sel_hi:[1,1,1]
    v_rcp_f32 v228, v228
    v_rcp_f32 v229, v229
    v_rcp_f32 v230, v230
    v_rcp_f32 v231, v231
    v_rcp_f32 v232, v232
    v_rcp_f32 v233, v233
    v_rcp_f32 v234, v234
    v_rcp_f32 v235, v235
    v_pk_mul_f32 v[140:141], v[140:141], v[228:229]
    v_pk_mul_f32 v[142:143], v[142:143], v[230:231]
    v_pk_mul_f32 v[144:145], v[144:145], v[232:233]
    v_pk_mul_f32 v[146:147], v[146:147], v[234:235]
    v_pk_fma_f32 v[148:149], v[72:73], v[124:125], v[148:149] op_sel:[0,0,0] op_sel_hi:[1,0,1]
    v_pk_fma_f32 v[150:151], v[74:75], v[124:125], v[150:151] op_sel:[0,0,0] op_sel_hi:[1,0,1]
    v_pk_fma_f32 v[152:153], v[72:73], v[128:129], v[152:153] op_sel:[0,0,0] op_sel_hi:[1,0,1]
    v_pk_fma_f32 v[154:155], v[74:75], v[128:129], v[154:155] op_sel:[0,0,0] op_sel_hi:[1,0,1]
    v_pk_mul_f32 v[228:229], v[148:149], v[148:149]
    v_pk_mul_f32 v[230:231], v[150:151], v[150:151]
    v_pk_mul_f32 v[232:233], v[152:153], v[152:153]
    v_pk_mul_f32 v[234:235], v[154:155], v[154:155]
    v_pk_fma_f32 v[228:229], v[228:229], v[124:125], v[126:127] op_sel:[0,1,0] op_sel_hi:[1,1,0]
    v_pk_fma_f32 v[230:231], v[230:231], v[124:125], v[126:127] op_sel:[0,1,0] op_sel_hi:[1,1,0]
    v_pk_fma_f32 v[232:233], v[232:233], v[128:129], v[130:131] op_sel:[0,1,0] op_sel_hi:[1,1,0]
    v_pk_fma_f32 v[234:235], v[234:235], v[128:129], v[130:131] op_sel:[0,1,0] op_sel_hi:[1,1,0]
    v_pk_mul_f32 v[228:229], v[228:229], v[148:149]
    v_pk_mul_f32 v[230:231], v[230:231], v[150:151]
    v_pk_mul_f32 v[232:233], v[232:233], v[152:153]
    v_pk_mul_f32 v[234:235], v[234:235], v[154:155]
    v_exp_f32 v228, v228
    v_exp_f32 v229, v229
    v_exp_f32 v230, v230
    v_exp_f32 v231, v231
    v_exp_f32 v232, v232
    v_exp_f32 v233, v233
    v_exp_f32 v234, v234
    v_exp_f32 v235, v235
    v_pk_fma_f32 v[228:229], v[228:229], v[126:127], v[126:127] op_sel:[0,1,1] op_sel_hi:[1,1,1]
    v_pk_fma_f32 v[230:231], v[230:231], v[126:127], v[126:127] op_sel:[0,1,1] op_sel_hi:[1,1,1]
    v_pk_fma_f32 v[232:233], v[232:233], v[130:131], v[130:131] op_sel:[0,1,1] op_sel_hi:[1,1,1]
    v_pk_fma_f32 v[234:235], v[234:235], v[130:131], v[130:131] op_sel:[0,1,1] op_sel_hi:[1,1,1]
    v_rcp_f32 v228, v228
    v_rcp_f32 v229, v229
    v_rcp_f32 v230, v230
    v_rcp_f32 v231, v231
    v_rcp_f32 v232, v232
    v_rcp_f32 v233, v233
    v_rcp_f32 v234, v234
    v_rcp_f32 v235, v235
    v_pk_mul_f32 v[148:149], v[148:149], v[228:229]
    v_pk_mul_f32 v[150:151], v[150:151], v[230:231]
    v_pk_mul_f32 v[152:153], v[152:153], v[232:233]
    v_pk_mul_f32 v[154:155], v[154:155], v[234:235]
    v_pk_fma_f32 v[156:157], v[76:77], v[124:125], v[156:157] op_sel:[0,0,0] op_sel_hi:[1,0,1]
    v_pk_fma_f32 v[158:159], v[78:79], v[124:125], v[158:159] op_sel:[0,0,0] op_sel_hi:[1,0,1]
    v_pk_fma_f32 v[160:161], v[76:77], v[128:129], v[160:161] op_sel:[0,0,0] op_sel_hi:[1,0,1]
    v_pk_fma_f32 v[162:163], v[78:79], v[128:129], v[162:163] op_sel:[0,0,0] op_sel_hi:[1,0,1]
    v_pk_mul_f32 v[228:229], v[156:157], v[156:157]
    v_pk_mul_f32 v[230:231], v[158:159], v[158:159]
    v_pk_mul_f32 v[232:233], v[160:161], v[160:161]
    v_pk_mul_f32 v[234:235], v[162:163], v[162:163]
    v_pk_fma_f32 v[228:229], v[228:229], v[124:125], v[126:127] op_sel:[0,1,0] op_sel_hi:[1,1,0]
    v_pk_fma_f32 v[230:231], v[230:231], v[124:125], v[126:127] op_sel:[0,1,0] op_sel_hi:[1,1,0]
    v_pk_fma_f32 v[232:233], v[232:233], v[128:129], v[130:131] op_sel:[0,1,0] op_sel_hi:[1,1,0]
    v_pk_fma_f32 v[234:235], v[234:235], v[128:129], v[130:131] op_sel:[0,1,0] op_sel_hi:[1,1,0]
    v_pk_mul_f32 v[228:229], v[228:229], v[156:157]
    v_pk_mul_f32 v[230:231], v[230:231], v[158:159]
    v_pk_mul_f32 v[232:233], v[232:233], v[160:161]
    v_pk_mul_f32 v[234:235], v[234:235], v[162:163]
    v_exp_f32 v228, v228
    v_exp_f32 v229, v229
    v_exp_f32 v230, v230
    v_exp_f32 v231, v231
    v_exp_f32 v232, v232
    v_exp_f32 v233, v233
    v_exp_f32 v234, v234
    v_exp_f32 v235, v235
    v_pk_fma_f32 v[228:229], v[228:229], v[126:127], v[126:127] op_sel:[0,1,1] op_sel_hi:[1,1,1]
    v_pk_fma_f32 v[230:231], v[230:231], v[126:127], v[126:127] op_sel:[0,1,1] op_sel_hi:[1,1,1]
    v_pk_fma_f32 v[232:233], v[232:233], v[130:131], v[130:131] op_sel:[0,1,1] op_sel_hi:[1,1,1]
    v_pk_fma_f32 v[234:235], v[234:235], v[130:131], v[130:131] op_sel:[0,1,1] op_sel_hi:[1,1,1]
    v_rcp_f32 v228, v228
    v_rcp_f32 v229, v229
    v_rcp_f32 v230, v230
    v_rcp_f32 v231, v231
    v_rcp_f32 v232, v232
    v_rcp_f32 v233, v233
    v_rcp_f32 v234, v234
    v_rcp_f32 v235, v235
    v_pk_mul_f32 v[156:157], v[156:157], v[228:229]
    v_pk_mul_f32 v[158:159], v[158:159], v[230:231]
    v_pk_mul_f32 v[160:161], v[160:161], v[232:233]
    v_pk_mul_f32 v[162:163], v[162:163], v[234:235]
    v_pk_fma_f32 v[164:165], v[80:81], v[124:125], v[164:165] op_sel:[0,0,0] op_sel_hi:[1,0,1]
    v_pk_fma_f32 v[166:167], v[82:83], v[124:125], v[166:167] op_sel:[0,0,0] op_sel_hi:[1,0,1]
    v_pk_fma_f32 v[168:169], v[80:81], v[128:129], v[168:169] op_sel:[0,0,0] op_sel_hi:[1,0,1]
    v_pk_fma_f32 v[170:171], v[82:83], v[128:129], v[170:171] op_sel:[0,0,0] op_sel_hi:[1,0,1]
    v_pk_mul_f32 v[228:229], v[164:165], v[164:165]
    v_pk_mul_f32 v[230:231], v[166:167], v[166:167]
    v_pk_mul_f32 v[232:233], v[168:169], v[168:169]
    v_pk_mul_f32 v[234:235], v[170:171], v[170:171]
    v_pk_fma_f32 v[228:229], v[228:229], v[124:125], v[126:127] op_sel:[0,1,0] op_sel_hi:[1,1,0]
    v_pk_fma_f32 v[230:231], v[230:231], v[124:125], v[126:127] op_sel:[0,1,0] op_sel_hi:[1,1,0]
    v_pk_fma_f32 v[232:233], v[232:233], v[128:129], v[130:131] op_sel:[0,1,0] op_sel_hi:[1,1,0]
    v_pk_fma_f32 v[234:235], v[234:235], v[128:129], v[130:131] op_sel:[0,1,0] op_sel_hi:[1,1,0]
    v_pk_mul_f32 v[228:229], v[228:229], v[164:165]
    v_pk_mul_f32 v[230:231], v[230:231], v[166:167]
    v_pk_mul_f32 v[232:233], v[232:233], v[168:169]
    v_pk_mul_f32 v[234:235], v[234:235], v[170:171]
    v_exp_f32 v228, v228
    v_exp_f32 v229, v229
    v_exp_f32 v230, v230
    v_exp_f32 v231, v231
    v_exp_f32 v232, v232
    v_exp_f32 v233, v233
    v_exp_f32 v234, v234
    v_exp_f32 v235, v235
    v_pk_fma_f32 v[228:229], v[228:229], v[126:127], v[126:127] op_sel:[0,1,1] op_sel_hi:[1,1,1]
    v_pk_fma_f32 v[230:231], v[230:231], v[126:127], v[126:127] op_sel:[0,1,1] op_sel_hi:[1,1,1]
    v_pk_fma_f32 v[232:233], v[232:233], v[130:131], v[130:131] op_sel:[0,1,1] op_sel_hi:[1,1,1]
    v_pk_fma_f32 v[234:235], v[234:235], v[130:131], v[130:131] op_sel:[0,1,1] op_sel_hi:[1,1,1]
    v_rcp_f32 v228, v228
    v_rcp_f32 v229, v229
    v_rcp_f32 v230, v230
    v_rcp_f32 v231, v231
    v_rcp_f32 v232, v232
    v_rcp_f32 v233, v233
    v_rcp_f32 v234, v234
    v_rcp_f32 v235, v235
    v_pk_mul_f32 v[164:165], v[164:165], v[228:229]
    v_pk_mul_f32 v[166:167], v[166:167], v[230:231]
    v_pk_mul_f32 v[168:169], v[168:169], v[232:233]
    v_pk_mul_f32 v[170:171], v[170:171], v[234:235]
    v_pk_fma_f32 v[172:173], v[84:85], v[124:125], v[172:173] op_sel:[0,0,0] op_sel_hi:[1,0,1]
    v_pk_fma_f32 v[174:175], v[86:87], v[124:125], v[174:175] op_sel:[0,0,0] op_sel_hi:[1,0,1]
    v_pk_fma_f32 v[176:177], v[84:85], v[128:129], v[176:177] op_sel:[0,0,0] op_sel_hi:[1,0,1]
    v_pk_fma_f32 v[178:179], v[86:87], v[128:129], v[178:179] op_sel:[0,0,0] op_sel_hi:[1,0,1]
    v_pk_mul_f32 v[228:229], v[172:173], v[172:173]
    v_pk_mul_f32 v[230:231], v[174:175], v[174:175]
    v_pk_mul_f32 v[232:233], v[176:177], v[176:177]
    v_pk_mul_f32 v[234:235], v[178:179], v[178:179]
    v_pk_fma_f32 v[228:229], v[228:229], v[124:125], v[126:127] op_sel:[0,1,0] op_sel_hi:[1,1,0]
    v_pk_fma_f32 v[230:231], v[230:231], v[124:125], v[126:127] op_sel:[0,1,0] op_sel_hi:[1,1,0]
    v_pk_fma_f32 v[232:233], v[232:233], v[128:129], v[130:131] op_sel:[0,1,0] op_sel_hi:[1,1,0]
    v_pk_fma_f32 v[234:235], v[234:235], v[128:129], v[130:131] op_sel:[0,1,0] op_sel_hi:[1,1,0]
    v_pk_mul_f32 v[228:229], v[228:229], v[172:173]
    v_pk_mul_f32 v[230:231], v[230:231], v[174:175]
    v_pk_mul_f32 v[232:233], v[232:233], v[176:177]
    v_pk_mul_f32 v[234:235], v[234:235], v[178:179]
    v_exp_f32 v228, v228
    v_exp_f32 v229, v229
    v_exp_f32 v230, v230
    v_exp_f32 v231, v231
    v_exp_f32 v232, v232
    v_exp_f32 v233, v233
    v_exp_f32 v234, v234
    v_exp_f32 v235, v235
    v_pk_fma_f32 v[228:229], v[228:229], v[126:127], v[126:127] op_sel:[0,1,1] op_sel_hi:[1,1,1]
    v_pk_fma_f32 v[230:231], v[230:231], v[126:127], v[126:127] op_sel:[0,1,1] op_sel_hi:[1,1,1]
    v_pk_fma_f32 v[232:233], v[232:233], v[130:131], v[130:131] op_sel:[0,1,1] op_sel_hi:[1,1,1]
    v_pk_fma_f32 v[234:235], v[234:235], v[130:131], v[130:131] op_sel:[0,1,1] op_sel_hi:[1,1,1]
    v_rcp_f32 v228, v228
    v_rcp_f32 v229, v229
    v_rcp_f32 v230, v230
    v_rcp_f32 v231, v231
    v_rcp_f32 v232, v232
    v_rcp_f32 v233, v233
    v_rcp_f32 v234, v234
    v_rcp_f32 v235, v235
    v_pk_mul_f32 v[172:173], v[172:173], v[228:229]
    v_pk_mul_f32 v[174:175], v[174:175], v[230:231]
    v_pk_mul_f32 v[176:177], v[176:177], v[232:233]
    v_pk_mul_f32 v[178:179], v[178:179], v[234:235]
    v_pk_fma_f32 v[180:181], v[88:89], v[124:125], v[180:181] op_sel:[0,0,0] op_sel_hi:[1,0,1]
    v_pk_fma_f32 v[182:183], v[90:91], v[124:125], v[182:183] op_sel:[0,0,0] op_sel_hi:[1,0,1]
    v_pk_fma_f32 v[184:185], v[88:89], v[128:129], v[184:185] op_sel:[0,0,0] op_sel_hi:[1,0,1]
    v_pk_fma_f32 v[186:187], v[90:91], v[128:129], v[186:187] op_sel:[0,0,0] op_sel_hi:[1,0,1]
    v_pk_mul_f32 v[228:229], v[180:181], v[180:181]
    v_pk_mul_f32 v[230:231], v[182:183], v[182:183]
    v_pk_mul_f32 v[232:233], v[184:185], v[184:185]
    v_pk_mul_f32 v[234:235], v[186:187], v[186:187]
    v_pk_fma_f32 v[228:229], v[228:229], v[124:125], v[126:127] op_sel:[0,1,0] op_sel_hi:[1,1,0]
    v_pk_fma_f32 v[230:231], v[230:231], v[124:125], v[126:127] op_sel:[0,1,0] op_sel_hi:[1,1,0]
    v_pk_fma_f32 v[232:233], v[232:233], v[128:129], v[130:131] op_sel:[0,1,0] op_sel_hi:[1,1,0]
    v_pk_fma_f32 v[234:235], v[234:235], v[128:129], v[130:131] op_sel:[0,1,0] op_sel_hi:[1,1,0]
    v_pk_mul_f32 v[228:229], v[228:229], v[180:181]
    v_pk_mul_f32 v[230:231], v[230:231], v[182:183]
    v_pk_mul_f32 v[232:233], v[232:233], v[184:185]
    v_pk_mul_f32 v[234:235], v[234:235], v[186:187]
    v_exp_f32 v228, v228
    v_exp_f32 v229, v229
    v_exp_f32 v230, v230
    v_exp_f32 v231, v231
    v_exp_f32 v232, v232
    v_exp_f32 v233, v233
    v_exp_f32 v234, v234
    v_exp_f32 v235, v235
    v_pk_fma_f32 v[228:229], v[228:229], v[126:127], v[126:127] op_sel:[0,1,1] op_sel_hi:[1,1,1]
    v_pk_fma_f32 v[230:231], v[230:231], v[126:127], v[126:127] op_sel:[0,1,1] op_sel_hi:[1,1,1]
    v_pk_fma_f32 v[232:233], v[232:233], v[130:131], v[130:131] op_sel:[0,1,1] op_sel_hi:[1,1,1]
    v_pk_fma_f32 v[234:235], v[234:235], v[130:131], v[130:131] op_sel:[0,1,1] op_sel_hi:[1,1,1]
    v_rcp_f32 v228, v228
    v_rcp_f32 v229, v229
    v_rcp_f32 v230, v230
    v_rcp_f32 v231, v231
    v_rcp_f32 v232, v232
    v_rcp_f32 v233, v233
    v_rcp_f32 v234, v234
    v_rcp_f32 v235, v235
    v_pk_mul_f32 v[180:181], v[180:181], v[228:229]
    v_pk_mul_f32 v[182:183], v[182:183], v[230:231]
    v_pk_mul_f32 v[184:185], v[184:185], v[232:233]
    v_pk_mul_f32 v[186:187], v[186:187], v[234:235]
    v_pk_fma_f32 v[188:189], v[92:93], v[124:125], v[188:189] op_sel:[0,0,0] op_sel_hi:[1,0,1]
    v_pk_fma_f32 v[190:191], v[94:95], v[124:125], v[190:191] op_sel:[0,0,0] op_sel_hi:[1,0,1]
    v_pk_fma_f32 v[192:193], v[92:93], v[128:129], v[192:193] op_sel:[0,0,0] op_sel_hi:[1,0,1]
    v_pk_fma_f32 v[194:195], v[94:95], v[128:129], v[194:195] op_sel:[0,0,0] op_sel_hi:[1,0,1]
    v_pk_mul_f32 v[228:229], v[188:189], v[188:189]
    v_pk_mul_f32 v[230:231], v[190:191], v[190:191]
    v_pk_mul_f32 v[232:233], v[192:193], v[192:193]
    v_pk_mul_f32 v[234:235], v[194:195], v[194:195]
    v_pk_fma_f32 v[228:229], v[228:229], v[124:125], v[126:127] op_sel:[0,1,0] op_sel_hi:[1,1,0]
    v_pk_fma_f32 v[230:231], v[230:231], v[124:125], v[126:127] op_sel:[0,1,0] op_sel_hi:[1,1,0]
    v_pk_fma_f32 v[232:233], v[232:233], v[128:129], v[130:131] op_sel:[0,1,0] op_sel_hi:[1,1,0]
    v_pk_fma_f32 v[234:235], v[234:235], v[128:129], v[130:131] op_sel:[0,1,0] op_sel_hi:[1,1,0]
    v_pk_mul_f32 v[228:229], v[228:229], v[188:189]
    v_pk_mul_f32 v[230:231], v[230:231], v[190:191]
    v_pk_mul_f32 v[232:233], v[232:233], v[192:193]
    v_pk_mul_f32 v[234:235], v[234:235], v[194:195]
    v_exp_f32 v228, v228
    v_exp_f32 v229, v229
    v_exp_f32 v230, v230
    v_exp_f32 v231, v231
    v_exp_f32 v232, v232
    v_exp_f32 v233, v233
    v_exp_f32 v234, v234
    v_exp_f32 v235, v235
    v_pk_fma_f32 v[228:229], v[228:229], v[126:127], v[126:127] op_sel:[0,1,1] op_sel_hi:[1,1,1]
    v_pk_fma_f32 v[230:231], v[230:231], v[126:127], v[126:127] op_sel:[0,1,1] op_sel_hi:[1,1,1]
    v_pk_fma_f32 v[232:233], v[232:233], v[130:131], v[130:131] op_sel:[0,1,1] op_sel_hi:[1,1,1]
    v_pk_fma_f32 v[234:235], v[234:235], v[130:131], v[130:131] op_sel:[0,1,1] op_sel_hi:[1,1,1]
    v_rcp_f32 v228, v228
    v_rcp_f32 v229, v229
    v_rcp_f32 v230, v230
    v_rcp_f32 v231, v231
    v_rcp_f32 v232, v232
    v_rcp_f32 v233, v233
    v_rcp_f32 v234, v234
    v_rcp_f32 v235, v235
    v_pk_mul_f32 v[188:189], v[188:189], v[228:229]
    v_pk_mul_f32 v[190:191], v[190:191], v[230:231]
    v_pk_mul_f32 v[192:193], v[192:193], v[232:233]
    v_pk_mul_f32 v[194:195], v[194:195], v[234:235]
    s_mul_i32 s31, s34, 112
    s_mul_i32 s3, s35, 7
    s_add_u32 s31, s31, s3
    s_lshl_b32 s31, s31, 12
    s_lshl_b32 s3, s14, 10
    s_add_u32 s31, s31, s3
    s_add_u32 s31, s31, 30408704
    s_lshl_b32 s3, s35, 2
    s_lshl_b32 s33, s34, 9
    s_add_u32 s33, s33, s3
    s_add_u32 s33, s33, 46202880
    s_mov_b32 s52, 0xffff0000
    s_mov_b32 s53, 0xffff0000
    s_lshl_b32 s48, s34, 4
    s_add_u32 s48, s48, s35
    s_lshl_b32 s48, s48, 3
    s_add_u32 s48, s48, s14
    s_lshl_b32 s48, s48, 11
    s_add_u32 s48, s48, 9437184
    s_add_u32 s49, s48, 8192
    buffer_load_dwordx4 v[204:207], v2, s[20:23], s48 offen offset:0 sc1
    buffer_load_dwordx4 v[208:211], v2, s[20:23], s49 offen offset:0 sc1
    buffer_load_dwordx4 v[212:215], v2, s[20:23], s48 offen offset:1024 sc1
    buffer_load_dwordx4 v[216:219], v2, s[20:23], s49 offen offset:1024 sc1
    s_barrier
    ds_read_b128 v[124:127], v9 offset:0
    ds_read_b128 v[128:131], v9 offset:1024
    ds_read_b128 v[68:71], v7 offset:0
    ds_read_b128 v[72:75], v7 offset:1024
    ds_read_b128 v[76:79], v7 offset:2048
    ds_read_b128 v[80:83], v7 offset:3072
    ds_read_b128 v[84:87], v7 offset:4096
    ds_read_b128 v[88:91], v7 offset:5120
    ds_read_b128 v[92:95], v7 offset:6144
    s_mov_b32 s15, 31
L_loop_59:
    s_waitcnt lgkmcnt(0)
    v_mfma_f32_16x16x32_bf16 v[12:15], v[68:71], v[124:127], v[12:15]
    ds_read_b128 v[132:135], v9 offset:8192
    ds_read_b128 v[136:139], v9 offset:9216
    v_mfma_f32_16x16x32_bf16 v[16:19], v[68:71], v[128:131], v[16:19]
    ds_read_b128 v[96:99], v7 offset:7168
    ds_read_b128 v[100:103], v7 offset:8192
    v_mfma_f32_16x16x32_bf16 v[20:23], v[72:75], v[124:127], v[20:23]
    ds_read_b128 v[104:107], v7 offset:9216
    ds_read_b128 v[108:111], v7 offset:10240
    v_mfma_f32_16x16x32_bf16 v[24:27], v[72:75], v[128:131], v[24:27]
    ds_read_b128 v[112:115], v7 offset:11264
    v_mfma_f32_16x16x32_bf16 v[28:31], v[76:79], v[124:127], v[28:31]
    ds_read_b128 v[116:119], v7 offset:12288
    ds_read_b128 v[120:123], v7 offset:13312
    v_mfma_f32_16x16x32_bf16 v[32:35], v[76:79], v[128:131], v[32:35]
    v_add_u32 v9, s39, v8
    s_add_u32 s39, s39, 16384
    v_mfma_f32_16x16x32_bf16 v[36:39], v[80:83], v[124:127], v[36:39]
    s_cmp_eq_u32 s39, 81920
    v_mfma_f32_16x16x32_bf16 v[40:43], v[80:83], v[128:131], v[40:43]
    s_cselect_b32 s39, 0, s39
    v_add_u32 v7, s38, v6
    v_mfma_f32_16x16x32_bf16 v[44:47], v[84:87], v[124:127], v[44:47]
    s_add_u32 s38, s38, 14336
    s_cmp_eq_u32 s38, 153600
    v_mfma_f32_16x16x32_bf16 v[48:51], v[84:87], v[128:131], v[48:51]
    s_cselect_b32 s38, 81920, s38
    v_mfma_f32_16x16x32_bf16 v[52:55], v[88:91], v[124:127], v[52:55]
    v_mfma_f32_16x16x32_bf16 v[56:59], v[88:91], v[128:131], v[56:59]
    v_mfma_f32_16x16x32_bf16 v[60:63], v[92:95], v[124:127], v[60:63]
    v_mfma_f32_16x16x32_bf16 v[64:67], v[92:95], v[128:131], v[64:67]
    s_waitcnt lgkmcnt(0)
    s_barrier
    v_mfma_f32_16x16x32_bf16 v[12:15], v[96:99], v[132:135], v[12:15]
    ds_read_b128 v[124:127], v9 offset:0
    ds_read_b128 v[128:131], v9 offset:1024
    v_mfma_f32_16x16x32_bf16 v[16:19], v[96:99], v[136:139], v[16:19]
    ds_read_b128 v[68:71], v7 offset:0
    v_mfma_f32_16x16x32_bf16 v[20:23], v[100:103], v[132:135], v[20:23]
    ds_read_b128 v[72:75], v7 offset:1024
    v_mfma_f32_16x16x32_bf16 v[24:27], v[100:103], v[136:139], v[24:27]
    ds_read_b128 v[76:79], v7 offset:2048
    v_mfma_f32_16x16x32_bf16 v[28:31], v[104:107], v[132:135], v[28:31]
    ds_read_b128 v[80:83], v7 offset:3072
    v_mfma_f32_16x16x32_bf16 v[32:35], v[104:107], v[136:139], v[32:35]
    ds_read_b128 v[84:87], v7 offset:4096
    v_mfma_f32_16x16x32_bf16 v[36:39], v[108:111], v[132:135], v[36:39]
    ds_read_b128 v[88:91], v7 offset:5120
    v_mfma_f32_16x16x32_bf16 v[40:43], v[108:111], v[136:139], v[40:43]
    ds_read_b128 v[92:95], v7 offset:6144
    v_mfma_f32_16x16x32_bf16 v[44:47], v[112:115], v[132:135], v[44:47]
    s_sub_u32 s15, s15, 1
    v_mfma_f32_16x16x32_bf16 v[48:51], v[112:115], v[136:139], v[48:51]
    s_cmp_lg_u32 s15, 0
    v_mfma_f32_16x16x32_bf16 v[52:55], v[116:119], v[132:135], v[52:55]
    v_mfma_f32_16x16x32_bf16 v[56:59], v[116:119], v[136:139], v[56:59]
    v_mfma_f32_16x16x32_bf16 v[60:63], v[120:123], v[132:135], v[60:63]
    v_mfma_f32_16x16x32_bf16 v[64:67], v[120:123], v[136:139], v[64:67]
    s_cbranch_scc1 L_loop_59
    s_waitcnt lgkmcnt(0)
    v_mfma_f32_16x16x32_bf16 v[12:15], v[68:71], v[124:127], v[12:15]
    ds_read_b128 v[132:135], v9 offset:8192
    v_mfma_f32_16x16x32_bf16 v[16:19], v[68:71], v[128:131], v[16:19]
    ds_read_b128 v[136:139], v9 offset:9216
    v_mfma_f32_16x16x32_bf16 v[20:23], v[72:75], v[124:127], v[20:23]
    ds_read_b128 v[96:99], v7 offset:7168
    v_mfma_f32_16x16x32_bf16 v[24:27], v[72:75], v[128:131], v[24:27]
    ds_read_b128 v[100:103], v7 offset:8192
    v_mfma_f32_16x16x32_bf16 v[28:31], v[76:79], v[124:127], v[28:31]
    ds_read_b128 v[104:107], v7 offset:9216
    v_mfma_f32_16x16x32_bf16 v[32:35], v[76:79], v[128:131], v[32:35]
    ds_read_b128 v[108:111], v7 offset:10240
    v_mfma_f32_16x16x32_bf16 v[36:39], v[80:83], v[124:127], v[36:39]
    ds_read_b128 v[112:115], v7 offset:11264
    v_mfma_f32_16x16x32_bf16 v[40:43], v[80:83], v[128:131], v[40:43]
    ds_read_b128 v[116:119], v7 offset:12288
    v_mfma_f32_16x16x32_bf16 v[44:47], v[84:87], v[124:127], v[44:47]
    ds_read_b128 v[120:123], v7 offset:13312
    v_mfma_f32_16x16x32_bf16 v[48:51], v[84:87], v[128:131], v[48:51]
    v_mfma_f32_16x16x32_bf16 v[52:55], v[88:91], v[124:127], v[52:55]
    v_mfma_f32_16x16x32_bf16 v[56:59], v[88:91], v[128:131], v[56:59]
    v_mfma_f32_16x16x32_bf16 v[60:63], v[92:95], v[124:127], v[60:63]
    v_mfma_f32_16x16x32_bf16 v[64:67], v[92:95], v[128:131], v[64:67]
    s_waitcnt lgkmcnt(0)
    s_barrier
    v_mfma_f32_16x16x32_bf16 v[12:15], v[96:99], v[132:135], v[12:15]
    v_mfma_f32_16x16x32_bf16 v[16:19], v[96:99], v[136:139], v[16:19]
    v_mfma_f32_16x16x32_bf16 v[20:23], v[100:103], v[132:135], v[20:23]
    v_mfma_f32_16x16x32_bf16 v[24:27], v[100:103], v[136:139], v[24:27]
    v_mfma_f32_16x16x32_bf16 v[28:31], v[104:107], v[132:135], v[28:31]
    v_mfma_f32_16x16x32_bf16 v[32:35], v[104:107], v[136:139], v[32:35]
    v_mfma_f32_16x16x32_bf16 v[36:39], v[108:111], v[132:135], v[36:39]
    v_mfma_f32_16x16x32_bf16 v[40:43], v[108:111], v[136:139], v[40:43]
    v_mfma_f32_16x16x32_bf16 v[44:47], v[112:115], v[132:135], v[44:47]
    v_mfma_f32_16x16x32_bf16 v[48:51], v[112:115], v[136:139], v[48:51]
    v_mfma_f32_16x16x32_bf16 v[52:55], v[116:119], v[132:135], v[52:55]
    v_mfma_f32_16x16x32_bf16 v[56:59], v[116:119], v[136:139], v[56:59]
    v_mfma_f32_16x16x32_bf16 v[60:63], v[120:123], v[132:135], v[60:63]
    v_mfma_f32_16x16x32_bf16 v[64:67], v[120:123], v[136:139], v[64:67]
    .p2align 3
    v_pk_mul_f32 v[12:13], v[140:141], v[12:13]
    v_pk_mul_f32 v[14:15], v[142:143], v[14:15]
    v_pk_mul_f32 v[16:17], v[144:145], v[16:17]
    v_pk_mul_f32 v[18:19], v[146:147], v[18:19]
    v_cvt_pk_bf16_f32 v140, v12, v13
    v_cvt_pk_bf16_f32 v141, v14, v15
    v_cvt_pk_bf16_f32 v142, v16, v17
    v_cvt_pk_bf16_f32 v143, v18, v19
    s_mov_b64 exec, s[52:53]
    v_swap_b32 v140, v142
    v_swap_b32 v141, v143
    s_mov_b64 exec, -1
    buffer_store_dwordx4 v[140:143], v2, s[20:23], s31 offen sc1
    s_add_u32 s31, s31, 4096
    v_pk_mul_f32 v[20:21], v[148:149], v[20:21]
    v_pk_mul_f32 v[22:23], v[150:151], v[22:23]
    v_pk_mul_f32 v[24:25], v[152:153], v[24:25]
    v_pk_mul_f32 v[26:27], v[154:155], v[26:27]
    v_cvt_pk_bf16_f32 v148, v20, v21
    v_cvt_pk_bf16_f32 v149, v22, v23
    v_cvt_pk_bf16_f32 v150, v24, v25
    v_cvt_pk_bf16_f32 v151, v26, v27
    s_mov_b64 exec, s[52:53]
    v_swap_b32 v148, v150
    v_swap_b32 v149, v151
    s_mov_b64 exec, -1
    buffer_store_dwordx4 v[148:151], v2, s[20:23], s31 offen sc1
    s_add_u32 s31, s31, 4096
    v_pk_mul_f32 v[28:29], v[156:157], v[28:29]
    v_pk_mul_f32 v[30:31], v[158:159], v[30:31]
    v_pk_mul_f32 v[32:33], v[160:161], v[32:33]
    v_pk_mul_f32 v[34:35], v[162:163], v[34:35]
    v_cvt_pk_bf16_f32 v156, v28, v29
    v_cvt_pk_bf16_f32 v157, v30, v31
    v_cvt_pk_bf16_f32 v158, v32, v33
    v_cvt_pk_bf16_f32 v159, v34, v35
    s_mov_b64 exec, s[52:53]
    v_swap_b32 v156, v158
    v_swap_b32 v157, v159
    s_mov_b64 exec, -1
    buffer_store_dwordx4 v[156:159], v2, s[20:23], s31 offen sc1
    s_add_u32 s31, s31, 4096
    v_pk_mul_f32 v[36:37], v[164:165], v[36:37]
    v_pk_mul_f32 v[38:39], v[166:167], v[38:39]
    v_pk_mul_f32 v[40:41], v[168:169], v[40:41]
    v_pk_mul_f32 v[42:43], v[170:171], v[42:43]
    v_cvt_pk_bf16_f32 v164, v36, v37
    v_cvt_pk_bf16_f32 v165, v38, v39
    v_cvt_pk_bf16_f32 v166, v40, v41
    v_cvt_pk_bf16_f32 v167, v42, v43
    s_mov_b64 exec, s[52:53]
    v_swap_b32 v164, v166
    v_swap_b32 v165, v167
    s_mov_b64 exec, -1
    buffer_store_dwordx4 v[164:167], v2, s[20:23], s31 offen sc1
    s_add_u32 s31, s31, 4096
    v_pk_mul_f32 v[44:45], v[172:173], v[44:45]
    v_pk_mul_f32 v[46:47], v[174:175], v[46:47]
    v_pk_mul_f32 v[48:49], v[176:177], v[48:49]
    v_pk_mul_f32 v[50:51], v[178:179], v[50:51]
    v_cvt_pk_bf16_f32 v172, v44, v45
    v_cvt_pk_bf16_f32 v173, v46, v47
    v_cvt_pk_bf16_f32 v174, v48, v49
    v_cvt_pk_bf16_f32 v175, v50, v51
    s_mov_b64 exec, s[52:53]
    v_swap_b32 v172, v174
    v_swap_b32 v173, v175
    s_mov_b64 exec, -1
    buffer_store_dwordx4 v[172:175], v2, s[20:23], s31 offen sc1
    s_add_u32 s31, s31, 4096
    v_pk_mul_f32 v[52:53], v[180:181], v[52:53]
    v_pk_mul_f32 v[54:55], v[182:183], v[54:55]
    v_pk_mul_f32 v[56:57], v[184:185], v[56:57]
    v_pk_mul_f32 v[58:59], v[186:187], v[58:59]
    v_cvt_pk_bf16_f32 v180, v52, v53
    v_cvt_pk_bf16_f32 v181, v54, v55
    v_cvt_pk_bf16_f32 v182, v56, v57
    v_cvt_pk_bf16_f32 v183, v58, v59
    s_mov_b64 exec, s[52:53]
    v_swap_b32 v180, v182
    v_swap_b32 v181, v183
    s_mov_b64 exec, -1
    buffer_store_dwordx4 v[180:183], v2, s[20:23], s31 offen sc1
    s_add_u32 s31, s31, 4096
    v_pk_mul_f32 v[60:61], v[188:189], v[60:61]
    v_pk_mul_f32 v[62:63], v[190:191], v[62:63]
    v_pk_mul_f32 v[64:65], v[192:193], v[64:65]
    v_pk_mul_f32 v[66:67], v[194:195], v[66:67]
    v_cvt_pk_bf16_f32 v188, v60, v61
    v_cvt_pk_bf16_f32 v189, v62, v63
    v_cvt_pk_bf16_f32 v190, v64, v65
    v_cvt_pk_bf16_f32 v191, v66, v67
    s_mov_b64 exec, s[52:53]
    v_swap_b32 v188, v190
    v_swap_b32 v189, v191
    s_mov_b64 exec, -1
    buffer_store_dwordx4 v[188:191], v2, s[20:23], s31 offen sc1
    s_mov_b32 s46, 0
    s_lshl_b32 s3, s14, 10
    v_add_u32 v6, s3, v2
    v_bfe_u32 v3, v1, 4, 1
    v_lshl_add_u32 v6, v3, 3, v6
    s_mov_b32 s47, 81920
    s_mov_b32 s3, 0
    v_add_u32 v9, s3, v2
    v_add_u32 v7, s46, v6
    v_xor_b32 v8, 8, v7
    s_add_u32 s46, s46, 16384
    s_cmp_eq_u32 s46, 65536
    s_cselect_b32 s46, 0, s46
    v_add_u32 v10, s47, v9
    s_add_u32 s47, s47, 8192
    s_cmp_eq_u32 s47, 163840
    s_cselect_b32 s47, 81920, s47
    s_lshl_b32 s3, s34, 9
    s_add_u32 s32, s3, 46202880
    v_lshlrev_b32 v3, 2, v1
    v_mov_b32 v4, 0
    s_cmp_lg_u32 s14, 0
    s_waitcnt vmcnt(0)
    s_barrier
    s_cbranch_scc1 L_rdy_60
    s_mov_b64 exec, 1
    v_mov_b32 v60, 1
    buffer_atomic_add v60, v4, s[20:23], s32 offen offset:256 sc0 sc1
    s_waitcnt vmcnt(0)
    v_cmp_eq_u32 vcc, 14, v60
    s_cbranch_vccnz L_wt_61x
L_wt_61:
    s_sleep 1
    v_mov_b32 v60, 0
    buffer_atomic_add v60, v4, s[20:23], s32 offen offset:256 sc0 sc1
    s_waitcnt vmcnt(0)
    v_cmp_ne_u32 vcc, 15, v60
    s_cbranch_vccnz L_wt_61
L_wt_61x:
    s_mov_b64 exec, -1
L_rdy_60:
    s_barrier
    v_lshlrev_b32 v12, 16, v204
    v_and_b32 v13, 0xffff0000, v204
    v_lshlrev_b32 v14, 16, v205
    v_and_b32 v15, 0xffff0000, v205
    v_lshlrev_b32 v20, 16, v206
    v_and_b32 v21, 0xffff0000, v206
    v_lshlrev_b32 v22, 16, v207
    v_and_b32 v23, 0xffff0000, v207
    v_lshlrev_b32 v28, 16, v208
    v_and_b32 v29, 0xffff0000, v208
    v_lshlrev_b32 v30, 16, v209
    v_and_b32 v31, 0xffff0000, v209
    v_lshlrev_b32 v36, 16, v210
    v_and_b32 v37, 0xffff0000, v210
    v_lshlrev_b32 v38, 16, v211
    v_and_b32 v39, 0xffff0000, v211
    v_lshlrev_b32 v16, 16, v212
    v_and_b32 v17, 0xffff0000, v212
    v_lshlrev_b32 v18, 16, v213
    v_and_b32 v19, 0xffff0000, v213
    v_lshlrev_b32 v24, 16, v214
    v_and_b32 v25, 0xffff0000, v214
    v_lshlrev_b32 v26, 16, v215
    v_and_b32 v27, 0xffff0000, v215
    v_lshlrev_b32 v32, 16, v216
    v_and_b32 v33, 0xffff0000, v216
    v_lshlrev_b32 v34, 16, v217
    v_and_b32 v35, 0xffff0000, v217
    v_lshlrev_b32 v40, 16, v218
    v_and_b32 v41, 0xffff0000, v218
    v_lshlrev_b32 v42, 16, v219
    v_and_b32 v43, 0xffff0000, v219
    v_lshrrev_b32 v5, 3, v1
    s_lshl_b32 s3, s14, 5
    v_add_u32 v5, s3, v5
    v_lshrrev_b32 v3, 4, v1
    v_and_b32 v4, 7, v1
    v_xor_b32 v3, v3, v4
    v_mul_u32_u24 v5, 2048, v5
    v_lshl_add_u32 v92, v3, 4, v5
    v_xor_b32 v93, 64, v92
    v_add_u32 v93, 15360, v93
    v_add_u32 v94, 30720, v92
    v_add_u32 v95, 30720, v93
    s_lshl_b32 s3, s14, 5
    s_lshl_b32 s3, s3, 7
    s_add_u32 s3, s3, 65536
    v_and_b32 v3, 15, v1
    v_lshlrev_b32 v97, 7, v3
    v_lshrrev_b32 v3, 1, v3
    v_lshrrev_b32 v4, 5, v1
    v_xor_b32 v3, v3, v4
    v_lshl_add_u32 v97, v3, 4, v97
    v_bfe_u32 v3, v1, 4, 1
    v_lshl_add_u32 v97, v3, 3, v97
    v_add_u32 v97, s3, v97
    v_xor_b32 v98, 32, v97
    v_xor_b32 v99, 64, v97
    v_xor_b32 v100, 96, v97
    s_mov_b64 s[40:41], s[12:13]
    s_mov_b32 s42, 4194304
    s_mov_b32 s43, 0x20000
    s_lshl_b32 s45, s34, 18
    s_lshl_b32 s3, s35, 7
    s_add_u32 s45, s45, s3
    s_lshl_b32 s3, s14, 12
    s_add_u32 s3, s3, 65536
    v_add_u32 v96, s3, v2
    s_barrier
    ds_read_b64 v[76:77], v7 offset:0
    ds_read_b64 v[78:79], v7 offset:4096
    ds_read_b64 v[80:81], v8 offset:0
    ds_read_b64 v[82:83], v8 offset:4096
    ds_read_b128 v[44:47], v10 offset:0
    ds_read_b128 v[48:51], v10 offset:1024
    ds_read_b128 v[52:55], v10 offset:2048
    ds_read_b128 v[56:59], v10 offset:3072
    s_mov_b32 s15, 27
L_loop_62:
    s_waitcnt lgkmcnt(0)
    v_mfma_f32_16x16x32_bf16 v[12:15], v[44:47], v[76:79], v[12:15]
    ds_read_b64 v[84:85], v7 offset:8192
    ds_read_b64 v[86:87], v7 offset:12288
    ds_read_b64 v[88:89], v8 offset:8192
    v_mfma_f32_16x16x32_bf16 v[16:19], v[44:47], v[80:83], v[16:19]
    ds_read_b64 v[90:91], v8 offset:12288
    ds_read_b128 v[60:63], v10 offset:4096
    ds_read_b128 v[64:67], v10 offset:5120
    v_mfma_f32_16x16x32_bf16 v[20:23], v[48:51], v[76:79], v[20:23]
    ds_read_b128 v[68:71], v10 offset:6144
    ds_read_b128 v[72:75], v10 offset:7168
    v_add_u32 v7, s46, v6
    v_mfma_f32_16x16x32_bf16 v[24:27], v[48:51], v[80:83], v[24:27]
    v_xor_b32 v8, 8, v7
    s_add_u32 s46, s46, 16384
    s_cmp_eq_u32 s46, 65536
    v_mfma_f32_16x16x32_bf16 v[28:31], v[52:55], v[76:79], v[28:31]
    s_cselect_b32 s46, 0, s46
    v_add_u32 v10, s47, v9
    s_add_u32 s47, s47, 8192
    v_mfma_f32_16x16x32_bf16 v[32:35], v[52:55], v[80:83], v[32:35]
    s_cmp_eq_u32 s47, 163840
    s_cselect_b32 s47, 81920, s47
    v_mfma_f32_16x16x32_bf16 v[36:39], v[56:59], v[76:79], v[36:39]
    v_mfma_f32_16x16x32_bf16 v[40:43], v[56:59], v[80:83], v[40:43]
    s_waitcnt lgkmcnt(0)
    s_barrier
    v_mfma_f32_16x16x32_bf16 v[12:15], v[60:63], v[84:87], v[12:15]
    ds_read_b64 v[76:77], v7 offset:0
    ds_read_b64 v[78:79], v7 offset:4096
    v_mfma_f32_16x16x32_bf16 v[16:19], v[60:63], v[88:91], v[16:19]
    ds_read_b64 v[80:81], v8 offset:0
    ds_read_b64 v[82:83], v8 offset:4096
    v_mfma_f32_16x16x32_bf16 v[20:23], v[64:67], v[84:87], v[20:23]
    ds_read_b128 v[44:47], v10 offset:0
    v_mfma_f32_16x16x32_bf16 v[24:27], v[64:67], v[88:91], v[24:27]
    ds_read_b128 v[48:51], v10 offset:1024
    ds_read_b128 v[52:55], v10 offset:2048
    v_mfma_f32_16x16x32_bf16 v[28:31], v[68:71], v[84:87], v[28:31]
    ds_read_b128 v[56:59], v10 offset:3072
    s_sub_u32 s15, s15, 1
    v_mfma_f32_16x16x32_bf16 v[32:35], v[68:71], v[88:91], v[32:35]
    s_cmp_lg_u32 s15, 0
    v_mfma_f32_16x16x32_bf16 v[36:39], v[72:75], v[84:87], v[36:39]
    v_mfma_f32_16x16x32_bf16 v[40:43], v[72:75], v[88:91], v[40:43]
    s_cbranch_scc1 L_loop_62
    s_waitcnt lgkmcnt(0)
    v_mfma_f32_16x16x32_bf16 v[12:15], v[44:47], v[76:79], v[12:15]
    ds_read_b64 v[84:85], v7 offset:8192
    ds_read_b64 v[86:87], v7 offset:12288
    v_mfma_f32_16x16x32_bf16 v[16:19], v[44:47], v[80:83], v[16:19]
    ds_read_b64 v[88:89], v8 offset:8192
    v_mfma_f32_16x16x32_bf16 v[20:23], v[48:51], v[76:79], v[20:23]
    ds_read_b64 v[90:91], v8 offset:12288
    v_mfma_f32_16x16x32_bf16 v[24:27], v[48:51], v[80:83], v[24:27]
    ds_read_b128 v[60:63], v10 offset:4096
    ds_read_b128 v[64:67], v10 offset:5120
    v_mfma_f32_16x16x32_bf16 v[28:31], v[52:55], v[76:79], v[28:31]
    ds_read_b128 v[68:71], v10 offset:6144
    v_mfma_f32_16x16x32_bf16 v[32:35], v[52:55], v[80:83], v[32:35]
    ds_read_b128 v[72:75], v10 offset:7168
    v_mfma_f32_16x16x32_bf16 v[36:39], v[56:59], v[76:79], v[36:39]
    v_mfma_f32_16x16x32_bf16 v[40:43], v[56:59], v[80:83], v[40:43]
    s_waitcnt lgkmcnt(0)
    v_mfma_f32_16x16x32_bf16 v[12:15], v[60:63], v[84:87], v[12:15]
    v_mfma_f32_16x16x32_bf16 v[16:19], v[60:63], v[88:91], v[16:19]
    v_mfma_f32_16x16x32_bf16 v[20:23], v[64:67], v[84:87], v[20:23]
    v_mfma_f32_16x16x32_bf16 v[24:27], v[64:67], v[88:91], v[24:27]
    v_mfma_f32_16x16x32_bf16 v[28:31], v[68:71], v[84:87], v[28:31]
    v_mfma_f32_16x16x32_bf16 v[32:35], v[68:71], v[88:91], v[32:35]
    v_mfma_f32_16x16x32_bf16 v[36:39], v[72:75], v[84:87], v[36:39]
    v_mfma_f32_16x16x32_bf16 v[40:43], v[72:75], v[88:91], v[40:43]
    s_nop 1
    v_cvt_pk_bf16_f32 v204, v12, v13
    v_cvt_pk_bf16_f32 v205, v14, v15
    ds_write_b64 v97, v[204:205] offset:0
    v_cvt_pk_bf16_f32 v206, v20, v21
    v_cvt_pk_bf16_f32 v207, v22, v23
    ds_write_b64 v98, v[206:207] offset:0
    v_cvt_pk_bf16_f32 v208, v28, v29
    v_cvt_pk_bf16_f32 v209, v30, v31
    ds_write_b64 v99, v[208:209] offset:0
    v_cvt_pk_bf16_f32 v210, v36, v37
    v_cvt_pk_bf16_f32 v211, v38, v39
    ds_write_b64 v100, v[210:211] offset:0
    ds_read_b128 v[44:47], v96 offset:0
    ds_read_b128 v[48:51], v96 offset:1024
    v_cvt_pk_bf16_f32 v212, v16, v17
    v_cvt_pk_bf16_f32 v213, v18, v19
    ds_write_b64 v97, v[212:213] offset:2048
    v_cvt_pk_bf16_f32 v214, v24, v25
    v_cvt_pk_bf16_f32 v215, v26, v27
    ds_write_b64 v98, v[214:215] offset:2048
    v_cvt_pk_bf16_f32 v216, v32, v33
    v_cvt_pk_bf16_f32 v217, v34, v35
    ds_write_b64 v99, v[216:217] offset:2048
    v_cvt_pk_bf16_f32 v218, v40, v41
    v_cvt_pk_bf16_f32 v219, v42, v43
    ds_write_b64 v100, v[218:219] offset:2048
    ds_read_b128 v[52:55], v96 offset:2048
    ds_read_b128 v[56:59], v96 offset:3072
    s_waitcnt lgkmcnt(6)
    buffer_store_dwordx4 v[44:47], v92, s[40:43], s45 offen offset:0 sc1
    buffer_store_dwordx4 v[48:51], v93, s[40:43], s45 offen offset:1024 sc1
    s_waitcnt lgkmcnt(1)
    buffer_store_dwordx4 v[52:55], v94, s[40:43], s45 offen offset:2048 sc1
    s_waitcnt lgkmcnt(0)
    buffer_store_dwordx4 v[56:59], v95, s[40:43], s45 offen offset:3072 sc1
L_end:
L_endx:
    s_endpgm
L_sig_17:
    s_lshr_b32 s3, s2, 4
    s_lshl_b32 s3, s3, 7
    s_and_b32 s60, s2, 15
    s_add_u32 s3, s3, s60
    s_lshl_b32 s3, s3, 2
    s_add_u32 s60, s3, 46268416
    v_mov_b32 v3, 0
    s_mov_b32 s57, 5
    s_cmp_lg_u32 s24, 3
    s_waitcnt vmcnt(0) lgkmcnt(0)
    s_cbranch_scc1 L_sig_17n
L_sig_17r:
    v_cmp_ne_u32 vcc, 0, v21
    s_cbranch_vccnz L_sig_17g
    s_sleep 2
    buffer_load_dword v21, v3, s[52:55], 0 offen sc1
    s_waitcnt vmcnt(0)
    s_branch L_sig_17r
L_sig_17n:
    s_barrier
    s_branch L_sigb_18
L_sig_17g:
    s_barrier
    s_mov_b64 exec, 1
    buffer_store_dword v3, v3, s[32:35], s60 offen sc1
    s_mov_b64 exec, -1
    s_cmp_lg_u32 s57, 0
    s_branch L_sigb_18
L_hook_51:
    s_cmp_lg_u32 s15, 12
    s_cbranch_scc1 L_hn_52
    buffer_load_dwordx4 v[196:199], v5, s[20:23], s48 offen sc1
    buffer_load_dwordx4 v[200:203], v5, s[20:23], s49 offen sc1
    buffer_load_dwordx4 v[204:207], v5, s[20:23], s50 offen sc1
    buffer_load_dwordx4 v[208:211], v5, s[20:23], s51 offen sc1
    s_branch L_back_50
L_hn_52:
    s_cmp_lg_u32 s15, 10
    s_cbranch_scc1 L_hn_53
L_gp_54:
    s_waitcnt vmcnt(0)
    v_max_u32 v3, v197, v199
    v_max3_u32 v3, v3, v201, v203
    v_max3_u32 v3, v3, v205, v207
    v_max3_u32 v3, v3, v209, v211
    v_cmp_eq_u32 vcc, -1, v3
    s_cbranch_vccz L_go_55
    s_sleep 4
    buffer_load_dwordx4 v[196:199], v5, s[20:23], s48 offen sc1
    buffer_load_dwordx4 v[200:203], v5, s[20:23], s49 offen sc1
    buffer_load_dwordx4 v[204:207], v5, s[20:23], s50 offen sc1
    buffer_load_dwordx4 v[208:211], v5, s[20:23], s51 offen sc1
    s_branch L_gp_54
L_go_55:
    v_pk_add_f32 v[196:197], v[196:197], v[204:205]
    v_pk_add_f32 v[198:199], v[198:199], v[206:207]
    v_pk_add_f32 v[200:201], v[200:201], v[208:209]
    v_pk_add_f32 v[202:203], v[202:203], v[210:211]
    v_pk_add_f32 v[196:197], v[196:197], v[200:201]
    v_pk_add_f32 v[198:199], v[198:199], v[202:203]
    v_mov_b32 v200, v196
    v_mov_b32 v201, v197
    v_mov_b32 v202, v198
    v_mov_b32 v203, v199
    s_nop 0
    v_permlane32_swap_b32 v196, v200
    v_permlane32_swap_b32 v197, v201
    v_permlane32_swap_b32 v198, v202
    v_permlane32_swap_b32 v199, v203
    s_nop 0
    v_pk_add_f32 v[196:197], v[196:197], v[200:201]
    v_pk_add_f32 v[198:199], v[198:199], v[202:203]
    v_mov_b32 v200, v196
    v_mov_b32 v201, v197
    v_mov_b32 v202, v198
    v_mov_b32 v203, v199
    s_nop 0
    v_permlane16_swap_b32 v196, v200
    v_permlane16_swap_b32 v197, v201
    v_permlane16_swap_b32 v198, v202
    v_permlane16_swap_b32 v199, v203
    s_nop 0
    v_pk_add_f32 v[196:197], v[196:197], v[200:201]
    v_pk_add_f32 v[198:199], v[198:199], v[202:203]
    v_mul_f32 v196, 0x3a124925, v196
    v_mul_f32 v197, 0x3a124925, v197
    v_fma_f32 v197, -v196, v196, v197
    v_max_f32 v197, 0, v197
    v_add_f32 v197, 0x3727c5ac, v197
    v_mul_f32 v198, 0x3a124925, v198
    v_mul_f32 v199, 0x3a124925, v199
    v_fma_f32 v199, -v198, v198, v199
    v_max_f32 v199, 0, v199
    v_add_f32 v199, 0x3727c5ac, v199
    v_rsq_f32 v200, v197
    v_rsq_f32 v201, v199
    s_lshl_b32 s3, s14, 8
    s_add_u32 s3, s3, 162816
    v_lshl_add_u32 v3, v239, 1, s3
    v_mul_f32_e64 v202, -v196, v200
    v_mul_f32_e64 v203, -v198, v201
    v_add_u32 v4, s3, v238
    ds_write_b64 v3, v[200:201]
    ds_write_b64 v3, v[202:203] offset:128
    ds_read_b128 v[204:207], v4
    ds_read_b128 v[208:211], v4 offset:64
    ds_read_b128 v[212:215], v4 offset:128
    ds_read_b128 v[216:219], v4 offset:192
    s_lshl_b32 s44, s35, 6
    s_lshl_b32 s3, s34, 2
    s_add_u32 s44, s44, s3
    s_add_u32 s44, s44, s14
    s_mul_i32 s44, s44, 7168
    s_add_u32 s44, s44, 22020096
    s_waitcnt lgkmcnt(0)
    .p2align 3
    v_pk_fma_f32 v[12:13], v[12:13], v[204:205], v[212:213]
    v_pk_fma_f32 v[14:15], v[14:15], v[206:207], v[214:215]
    v_pk_fma_f32 v[16:17], v[16:17], v[208:209], v[216:217]
    v_pk_fma_f32 v[18:19], v[18:19], v[210:211], v[218:219]
    v_cvt_pk_bf16_f32 v228, v12, v13
    v_cvt_pk_bf16_f32 v229, v14, v15
    v_cvt_pk_bf16_f32 v230, v16, v17
    v_cvt_pk_bf16_f32 v231, v18, v19
    buffer_store_dwordx4 v[228:231], v2, s[20:23], s44 offen offset:0 sc1
    v_pk_fma_f32 v[20:21], v[20:21], v[204:205], v[212:213]
    v_pk_fma_f32 v[22:23], v[22:23], v[206:207], v[214:215]
    v_pk_fma_f32 v[24:25], v[24:25], v[208:209], v[216:217]
    v_pk_fma_f32 v[26:27], v[26:27], v[210:211], v[218:219]
    v_cvt_pk_bf16_f32 v232, v20, v21
    v_cvt_pk_bf16_f32 v233, v22, v23
    v_cvt_pk_bf16_f32 v234, v24, v25
    v_cvt_pk_bf16_f32 v235, v26, v27
    buffer_store_dwordx4 v[232:235], v2, s[20:23], s44 offen offset:1024 sc1
    v_pk_fma_f32 v[28:29], v[28:29], v[204:205], v[212:213]
    v_pk_fma_f32 v[30:31], v[30:31], v[206:207], v[214:215]
    v_pk_fma_f32 v[32:33], v[32:33], v[208:209], v[216:217]
    v_pk_fma_f32 v[34:35], v[34:35], v[210:211], v[218:219]
    v_cvt_pk_bf16_f32 v220, v28, v29
    v_cvt_pk_bf16_f32 v221, v30, v31
    v_cvt_pk_bf16_f32 v222, v32, v33
    v_cvt_pk_bf16_f32 v223, v34, v35
    buffer_store_dwordx4 v[220:223], v2, s[20:23], s44 offen offset:2048 sc1
    v_pk_fma_f32 v[36:37], v[36:37], v[204:205], v[212:213]
    v_pk_fma_f32 v[38:39], v[38:39], v[206:207], v[214:215]
    v_pk_fma_f32 v[40:41], v[40:41], v[208:209], v[216:217]
    v_pk_fma_f32 v[42:43], v[42:43], v[210:211], v[218:219]
    v_cvt_pk_bf16_f32 v224, v36, v37
    v_cvt_pk_bf16_f32 v225, v38, v39
    v_cvt_pk_bf16_f32 v226, v40, v41
    v_cvt_pk_bf16_f32 v227, v42, v43
    buffer_store_dwordx4 v[224:227], v2, s[20:23], s44 offen offset:3072 sc1
    v_pk_fma_f32 v[44:45], v[44:45], v[204:205], v[212:213]
    v_pk_fma_f32 v[46:47], v[46:47], v[206:207], v[214:215]
    v_pk_fma_f32 v[48:49], v[48:49], v[208:209], v[216:217]
    v_pk_fma_f32 v[50:51], v[50:51], v[210:211], v[218:219]
    v_cvt_pk_bf16_f32 v228, v44, v45
    v_cvt_pk_bf16_f32 v229, v46, v47
    v_cvt_pk_bf16_f32 v230, v48, v49
    v_cvt_pk_bf16_f32 v231, v50, v51
    s_add_u32 s44, s44, 4096
    buffer_store_dwordx4 v[228:231], v2, s[20:23], s44 offen offset:0 sc1
    v_pk_fma_f32 v[52:53], v[52:53], v[204:205], v[212:213]
    v_pk_fma_f32 v[54:55], v[54:55], v[206:207], v[214:215]
    v_pk_fma_f32 v[56:57], v[56:57], v[208:209], v[216:217]
    v_pk_fma_f32 v[58:59], v[58:59], v[210:211], v[218:219]
    v_cvt_pk_bf16_f32 v232, v52, v53
    v_cvt_pk_bf16_f32 v233, v54, v55
    v_cvt_pk_bf16_f32 v234, v56, v57
    v_cvt_pk_bf16_f32 v235, v58, v59
    buffer_store_dwordx4 v[232:235], v2, s[20:23], s44 offen offset:1024 sc1
    v_pk_fma_f32 v[60:61], v[60:61], v[204:205], v[212:213]
    v_pk_fma_f32 v[62:63], v[62:63], v[206:207], v[214:215]
    v_pk_fma_f32 v[64:65], v[64:65], v[208:209], v[216:217]
    v_pk_fma_f32 v[66:67], v[66:67], v[210:211], v[218:219]
    v_cvt_pk_bf16_f32 v220, v60, v61
    v_cvt_pk_bf16_f32 v221, v62, v63
    v_cvt_pk_bf16_f32 v222, v64, v65
    v_cvt_pk_bf16_f32 v223, v66, v67
    buffer_store_dwordx4 v[220:223], v2, s[20:23], s44 offen offset:2048 sc1
    s_branch L_back_50
L_hn_53:
    s_cmp_lg_u32 s15, 7
    s_cbranch_scc1 L_hn_56
    s_waitcnt vmcnt(0)
    v_pk_mov_b32 v[12:13], v[236:237], v[236:237] op_sel:[0,0]
    v_pk_mov_b32 v[14:15], v[236:237], v[236:237] op_sel:[0,0]
    v_pk_mov_b32 v[16:17], v[236:237], v[236:237] op_sel:[1,1]
    v_pk_mov_b32 v[18:19], v[236:237], v[236:237] op_sel:[1,1]
    v_pk_mov_b32 v[20:21], v[236:237], v[236:237] op_sel:[0,0]
    v_pk_mov_b32 v[22:23], v[236:237], v[236:237] op_sel:[0,0]
    v_pk_mov_b32 v[24:25], v[236:237], v[236:237] op_sel:[1,1]
    v_pk_mov_b32 v[26:27], v[236:237], v[236:237] op_sel:[1,1]
    v_pk_mov_b32 v[28:29], v[236:237], v[236:237] op_sel:[0,0]
    v_pk_mov_b32 v[30:31], v[236:237], v[236:237] op_sel:[0,0]
    v_pk_mov_b32 v[32:33], v[236:237], v[236:237] op_sel:[1,1]
    v_pk_mov_b32 v[34:35], v[236:237], v[236:237] op_sel:[1,1]
    v_pk_mov_b32 v[36:37], v[236:237], v[236:237] op_sel:[0,0]
    v_pk_mov_b32 v[38:39], v[236:237], v[236:237] op_sel:[0,0]
    v_pk_mov_b32 v[40:41], v[236:237], v[236:237] op_sel:[1,1]
    v_pk_mov_b32 v[42:43], v[236:237], v[236:237] op_sel:[1,1]
    v_pk_mov_b32 v[44:45], v[236:237], v[236:237] op_sel:[0,0]
    v_pk_mov_b32 v[46:47], v[236:237], v[236:237] op_sel:[0,0]
    v_pk_mov_b32 v[48:49], v[236:237], v[236:237] op_sel:[1,1]
    v_pk_mov_b32 v[50:51], v[236:237], v[236:237] op_sel:[1,1]
    v_pk_mov_b32 v[52:53], v[236:237], v[236:237] op_sel:[0,0]
    v_pk_mov_b32 v[54:55], v[236:237], v[236:237] op_sel:[0,0]
    v_pk_mov_b32 v[56:57], v[236:237], v[236:237] op_sel:[1,1]
    v_pk_mov_b32 v[58:59], v[236:237], v[236:237] op_sel:[1,1]
    v_pk_mov_b32 v[60:61], v[236:237], v[236:237] op_sel:[0,0]
    v_pk_mov_b32 v[62:63], v[236:237], v[236:237] op_sel:[0,0]
    v_pk_mov_b32 v[64:65], v[236:237], v[236:237] op_sel:[1,1]
    v_pk_mov_b32 v[66:67], v[236:237], v[236:237] op_sel:[1,1]
    s_branch L_back_50
L_hn_56:
    s_cmp_lg_u32 s14, 0
    v_mov_b32 v4, 0
    s_cbranch_scc1 L_nf_58
    s_mov_b64 exec, 1
    buffer_store_dword v4, v4, s[20:23], s33 offen sc1
    s_mov_b64 exec, -1
L_nf_58:
    s_branch L_back_50
L_hn_57:
Lz_sequential_preLN__grouped_kv_mqa__mixer_gmlp__prompt_kernel:
.section .rodata,"a"
.p2align 6
.amdhsa_kernel sequential_preLN__grouped_kv_mqa__mixer_gmlp__prompt_kernel
  .amdhsa_next_free_vgpr 240
  .amdhsa_next_free_sgpr 100
  .amdhsa_accum_offset 240
  .amdhsa_group_segment_fixed_size 0
  .amdhsa_kernarg_size 104
  .amdhsa_user_sgpr_count 2
  .amdhsa_user_sgpr_kernarg_segment_ptr 1
  .amdhsa_system_sgpr_workgroup_id_x 1
.end_amdhsa_kernel
```
